```python
import torch

def _softmax(x, axis=-1):
    return torch.softmax(x, dim=axis)
def _gelu(x):
    return torch.nn.functional.gelu(x, approximate="tanh")
def _silu(x):
    return torch.nn.functional.silu(x)
def _sigmoid(x):
    return torch.sigmoid(x)
def _layernorm(x, axis=-1, eps=1e-5):
    m = x.mean(dim=axis, keepdim=True)
    v = x.var(dim=axis, keepdim=True, unbiased=False)
    return (x - m) / torch.sqrt(v + eps)
def _scatter_add(tgt, idx, src, axis=0):
    return tgt.clone().index_add_(axis, idx, src)
def _segment_sum(src, seg, n):
    out = torch.zeros((n,) + src.shape[1:], dtype=src.dtype)
    return out.index_add_(0, seg, src)
def _pad(x, pw):
    flat = tuple(v for pair in reversed(pw) for v in pair)
    return torch.nn.functional.pad(x, flat)

kernel_name = 'recurrent_scan__ssm_conv_s5__mixer_s_mlp__prompt'

def setup_inputs():

    _w = (lambda a: (lambda t: t.to(torch.bfloat16) if t.is_floating_point() else t)(torch.as_tensor(a)))
    def _A_setup():
        B, S, D = 1, 2048, 640
        P = D
        Lambda_re = -0.5 * (lambda _x: torch.exp(torch.as_tensor(_x)))((lambda *s: torch.randn(*s, dtype=torch.bfloat16) * 0.2)(P))
        Lambda_im = (lambda *s: torch.randn(*s, dtype=torch.bfloat16) * 0.4)(P) * 1.0
        B_re = (lambda *s: torch.randn(*s, dtype=torch.bfloat16) * 0.2)(P, D) * (D ** -0.5)
        B_im = (lambda *s: torch.randn(*s, dtype=torch.bfloat16) * 0.2)(P, D) * (D ** -0.5)
        C_re = (lambda *s: torch.randn(*s, dtype=torch.bfloat16) * 0.2)(D, P) * (P ** -0.5)
        C_im = (lambda *s: torch.randn(*s, dtype=torch.bfloat16) * 0.2)(D, P) * (P ** -0.5)
        log_dt = (lambda *s: torch.randn(*s, dtype=torch.bfloat16) * 0.2)(P) * 0.3 - 2.0
        Dskip = (lambda *s: torch.randn(*s, dtype=torch.bfloat16) * 0.05)(D)
        return {
            "x": _w((lambda *s: torch.randn(*s, dtype=torch.bfloat16) * 0.05)(B, S, D)),
            "Lambda_re": _w(Lambda_re),
            "Lambda_im": _w(Lambda_im),
            "B_re": _w(B_re),
            "B_im": _w(B_im),
            "C_re": _w(C_re),
            "C_im": _w(C_im),
            "log_dt": _w(log_dt),
            "Dskip": _w(Dskip),
        }
    _A_in = _A_setup()

    def _B_setup():
        B, S, D, F = 1, 2048, 640, 1536
        return {
            "x":  _w((lambda *s: torch.randn(*s, dtype=torch.bfloat16) * 0.05)(B, S, D)),
            "w1": _w((lambda *s: torch.randn(*s, dtype=torch.bfloat16) * 3.2)(D, D) * (D ** -0.5)),
            "w2": _w((lambda *s: torch.randn(*s, dtype=torch.bfloat16) * 3.2)(D, D) * (D ** -0.5)),
            "w3": _w((lambda *s: torch.randn(*s, dtype=torch.bfloat16) * 3.2)(D, F) * (D ** -0.5)),
            "w4": _w((lambda *s: torch.randn(*s, dtype=torch.bfloat16) * 1.6)(F, D) * (F ** -0.5)),
        }
    _B_in = _B_setup()

    return {
        "A_x": _A_in["x"],
        "A_Lambda_re": _A_in["Lambda_re"],
        "A_Lambda_im": _A_in["Lambda_im"],
        "A_B_re": _A_in["B_re"],
        "A_B_im": _A_in["B_im"],
        "A_C_re": _A_in["C_re"],
        "A_C_im": _A_in["C_im"],
        "A_log_dt": _A_in["log_dt"],
        "A_Dskip": _A_in["Dskip"],
        "B_x": _B_in["x"],
        "B_w1": _B_in["w1"],
        "B_w2": _B_in["w2"],
        "B_w3": _B_in["w3"],
        "B_w4": _B_in["w4"],
    }

def reference(A_x, A_Lambda_re, A_Lambda_im, A_B_re, A_B_im, A_C_re, A_C_im, A_log_dt, A_Dskip, B_x, B_w1, B_w2, B_w3, B_w4):
    def _A_ref(x, Lambda_re, Lambda_im, B_re, B_im, C_re, C_im, log_dt, Dskip):
        Bsz, L, H = x.shape
        Lam = Lambda_re + 1j * Lambda_im
        Bmat = B_re + 1j * B_im
        Cmat = C_re + 1j * C_im
        dt = torch.exp(log_dt)
        Lam_bar = torch.exp(dt * Lam)
        B_bar = ((Lam_bar - 1.0) / Lam)[:, None] * Bmat
        Bu = torch.einsum("bld,pd->blp", x + 0j, B_bar)
        h = torch.zeros_like(Bu[:, 0, :])
        hs = []
        for t in range(L):
            h = Lam_bar[None, :] * h + Bu[:, t, :]
            hs.append(h)
        hseq = torch.stack(hs, 1)
        y = 2.0 * torch.einsum("blp,dp->bld", hseq, Cmat).real + x * Dskip[None, None, :]
        return y

    def _B_ref(x, w1, w2, w3, w4):
        B, S, D = x.shape
        h = _gelu(_layernorm(x, axis=-1) @ w1)
        c = D // 4
        g0 = _pad(h[:, :, 0*c:1*c], ((0, 0), (1, 0), (0, 0)))[:, :S, :]
        g1 = _pad(h[:, :, 1*c:2*c], ((0, 0), (0, 1), (0, 0)))[:, 1:, :]
        g2 = _pad(h[:, :, 2*c:3*c], ((0, 0), (2, 0), (0, 0)))[:, :S, :]
        g3 = _pad(h[:, :, 3*c:   ], ((0, 0), (0, 2), (0, 0)))[:, 2:, :]
        hs = torch.concatenate([g0, g1, g2, g3], axis=-1) @ w2
        x1 = x + hs
        h2 = _gelu(_layernorm(x1, axis=-1) @ w3) @ w4
        return x1 + h2

    x = A_x
    xn = _layernorm(x, axis=-1)
    s = _A_ref(xn, A_Lambda_re, A_Lambda_im, A_B_re, A_B_im, A_C_re, A_C_im, A_log_dt, A_Dskip)
    g = _silu(_B_ref(xn, B_w1, B_w2, B_w3, B_w4))
    return x + s * g
```

```asm
; @launch grid=(256,1,1) block=(512,1,1) lds=163840
.amdgcn_target "amdgcn-amd-amdhsa--gfx950"
.text
.globl recurrent_scan__ssm_conv_s5__mixer_s_mlp__prompt_kernel
.p2align 8
.type recurrent_scan__ssm_conv_s5__mixer_s_mlp__prompt_kernel,@function
recurrent_scan__ssm_conv_s5__mixer_s_mlp__prompt_kernel:
  s_cmp_ge_u32 s2, 256
  s_cbranch_scc1 L_exit
  s_load_dwordx16 s[16:31], s[0:1], 0
  s_load_dwordx16 s[32:47], s[0:1], 64
  s_load_dwordx2 s[48:49], s[0:1], 128
  v_lshrrev_b32 v1, 6, v0
  v_and_b32 v0, 63, v0
  v_readfirstlane_b32 s3, v1
  s_and_b32 s8, s2, 7
  s_lshr_b32 s9, s2, 3
  s_and_b32 s4, s9, 7
  s_lshr_b32 s9, s9, 3
  s_lshl_b32 s5, s8, 2
  s_add_u32 s5, s5, s9
  s_lshl_b32 s6, s5, 6
  s_and_b32 s51, s3, 3
  s_add_u32 s10, s8, s9
  s_add_u32 s10, s10, s4
  s_mul_i32 s11, s10, 52
  s_lshr_b32 s11, s11, 8
  s_mul_i32 s11, s11, 5
  s_sub_u32 s13, s10, s11
  s_cmp_lg_u32 s3, 7
  s_cbranch_scc1 L_nocpf
  s_getpc_b64 s[98:99]
L_pcref:
  s_lshr_b32 s96, s2, 3
  s_lshl_b32 s96, s96, 3
  v_add_u32 v5, s96, v0
  v_mov_b32 v6, (L_code_end-L_pcref)/128
  v_min_u32 v5, v5, v6
  v_lshlrev_b32 v5, 7, v5
  v_mov_b32 v7, s99
  v_add_co_u32 v6, vcc, s98, v5
  s_nop 1
  v_addc_co_u32 v7, vcc, 0, v7, vcc
  s_mov_b64 exec, 0xff
  global_load_dword v247, v[6:7], off
  s_mov_b64 exec, -1
L_nocpf:
  s_mov_b32 s14, 0x3f803f80
  s_mov_b32 s15, 0x00003f80
  s_mov_b32 s50, 0x3f800000
  s_waitcnt lgkmcnt(0)
  s_mov_b32 s56, s16
  s_and_b32 s57, s17, 0xffff
  s_mov_b32 s58, 2621440
  s_mov_b32 s59, 0x00020000
  v_lshrrev_b32 v2, 3, v0
  v_and_b32 v3, 7, v0
  s_lshl_b32 s8, s3, 3
  v_add_u32 v2, s8, v2
  v_add_u32 v4, s6, v2
  v_mul_u32_u24 v4, 1280, v4
  v_lshl_add_u32 v4, v3, 4, v4
  s_mov_b32 s12, s4
  s_lshl_b32 s11, s12, 7
  buffer_load_dwordx4 v[100:103], v4, s[56:59], s11 offen
  s_add_u32 s12, s12, 1
  s_cmp_eq_u32 s12, 10
  s_cselect_b32 s12, 0, s12
  s_lshl_b32 s11, s12, 7
  buffer_load_dwordx4 v[104:107], v4, s[56:59], s11 offen
  s_add_u32 s12, s12, 1
  s_cmp_eq_u32 s12, 10
  s_cselect_b32 s12, 0, s12
  s_lshl_b32 s11, s12, 7
  buffer_load_dwordx4 v[108:111], v4, s[56:59], s11 offen
  s_add_u32 s12, s12, 1
  s_cmp_eq_u32 s12, 10
  s_cselect_b32 s12, 0, s12
  s_lshl_b32 s11, s12, 7
  buffer_load_dwordx4 v[112:115], v4, s[56:59], s11 offen
  s_add_u32 s12, s12, 1
  s_cmp_eq_u32 s12, 10
  s_cselect_b32 s12, 0, s12
  s_lshl_b32 s11, s12, 7
  buffer_load_dwordx4 v[116:119], v4, s[56:59], s11 offen
  s_add_u32 s12, s12, 1
  s_cmp_eq_u32 s12, 10
  s_cselect_b32 s12, 0, s12
  s_lshl_b32 s11, s12, 7
  buffer_load_dwordx4 v[120:123], v4, s[56:59], s11 offen
  s_add_u32 s12, s12, 1
  s_cmp_eq_u32 s12, 10
  s_cselect_b32 s12, 0, s12
  s_lshl_b32 s11, s12, 7
  buffer_load_dwordx4 v[124:127], v4, s[56:59], s11 offen
  s_add_u32 s12, s12, 1
  s_cmp_eq_u32 s12, 10
  s_cselect_b32 s12, 0, s12
  s_lshl_b32 s11, s12, 7
  buffer_load_dwordx4 v[128:131], v4, s[56:59], s11 offen
  s_add_u32 s12, s12, 1
  s_cmp_eq_u32 s12, 10
  s_cselect_b32 s12, 0, s12
  s_lshl_b32 s11, s12, 7
  buffer_load_dwordx4 v[132:135], v4, s[56:59], s11 offen
  s_add_u32 s12, s12, 1
  s_cmp_eq_u32 s12, 10
  s_cselect_b32 s12, 0, s12
  s_lshl_b32 s11, s12, 7
  buffer_load_dwordx4 v[136:139], v4, s[56:59], s11 offen
  s_add_u32 s12, s12, 1
  s_cmp_eq_u32 s12, 10
  s_cselect_b32 s12, 0, s12
  s_load_dword s7, s[48:49], 0
  s_mov_b32 s52, s48
  s_and_b32 s53, s49, 0xffff
  s_mov_b32 s54, 268435456
  s_mov_b32 s55, 0x00020000
  s_mov_b32 s60, s36
  s_and_b32 s61, s37, 0xffff
  s_mov_b32 s62, 819200
  s_mov_b32 s63, 0x00020000
  s_cmp_lt_u32 s51, 2
  s_cselect_b32 s76, s22, s24
  s_cselect_b32 s77, s23, s25
  s_and_b32 s77, s77, 0xffff
  s_mov_b32 s78, 819200
  s_mov_b32 s79, 0x00020000
  s_cmp_lt_u32 s3, 4
  s_cbranch_scc1 L_pre_c
  v_add_u32 v27, 0, v0
  v_mul_u32_u24 v28, 6554, v27
  v_lshrrev_b32 v28, 16, v28
  v_mul_u32_u24 v29, 10, v28
  v_sub_u32 v29, v27, v29
  v_and_b32 v30, 0x13, v28
  v_and_b32 v31, 8, v28
  v_lshrrev_b32 v31, 1, v31
  v_or_b32 v30, v30, v31
  v_and_b32 v31, 4, v28
  v_lshlrev_b32 v31, 1, v31
  v_or_b32 v30, v30, v31
  v_mul_u32_u24 v30, 1280, v30
  v_lshl_add_u32 v11, v29, 4, v30
  v_add_u32 v27, 64, v0
  v_mul_u32_u24 v28, 6554, v27
  v_lshrrev_b32 v28, 16, v28
  v_mul_u32_u24 v29, 10, v28
  v_sub_u32 v29, v27, v29
  v_and_b32 v30, 0x13, v28
  v_and_b32 v31, 8, v28
  v_lshrrev_b32 v31, 1, v31
  v_or_b32 v30, v30, v31
  v_and_b32 v31, 4, v28
  v_lshlrev_b32 v31, 1, v31
  v_or_b32 v30, v30, v31
  v_mul_u32_u24 v30, 1280, v30
  v_lshl_add_u32 v12, v29, 4, v30
  v_subrev_u32 v12, 1024, v12
  v_add_u32 v27, 128, v0
  v_mul_u32_u24 v28, 6554, v27
  v_lshrrev_b32 v28, 16, v28
  v_mul_u32_u24 v29, 10, v28
  v_sub_u32 v29, v27, v29
  v_and_b32 v30, 0x13, v28
  v_and_b32 v31, 8, v28
  v_lshrrev_b32 v31, 1, v31
  v_or_b32 v30, v30, v31
  v_and_b32 v31, 4, v28
  v_lshlrev_b32 v31, 1, v31
  v_or_b32 v30, v30, v31
  v_mul_u32_u24 v30, 1280, v30
  v_lshl_add_u32 v13, v29, 4, v30
  v_subrev_u32 v13, 2048, v13
  v_add_u32 v27, 192, v0
  v_mul_u32_u24 v28, 6554, v27
  v_lshrrev_b32 v28, 16, v28
  v_mul_u32_u24 v29, 10, v28
  v_sub_u32 v29, v27, v29
  v_and_b32 v30, 0x13, v28
  v_and_b32 v31, 8, v28
  v_lshrrev_b32 v31, 1, v31
  v_or_b32 v30, v30, v31
  v_and_b32 v31, 4, v28
  v_lshlrev_b32 v31, 1, v31
  v_or_b32 v30, v30, v31
  v_mul_u32_u24 v30, 1280, v30
  v_lshl_add_u32 v14, v29, 4, v30
  v_subrev_u32 v14, 3072, v14
  v_add_u32 v27, 256, v0
  v_mul_u32_u24 v28, 6554, v27
  v_lshrrev_b32 v28, 16, v28
  v_mul_u32_u24 v29, 10, v28
  v_sub_u32 v29, v27, v29
  v_and_b32 v30, 0x13, v28
  v_and_b32 v31, 8, v28
  v_lshrrev_b32 v31, 1, v31
  v_or_b32 v30, v30, v31
  v_and_b32 v31, 4, v28
  v_lshlrev_b32 v31, 1, v31
  v_or_b32 v30, v30, v31
  v_mul_u32_u24 v30, 1280, v30
  v_lshl_add_u32 v15, v29, 4, v30
  s_mul_i32 s88, s51, 40960
  s_mul_i32 s8, s4, 160
  s_add_u32 s88, s88, s8
  s_mul_i32 s34, s51, 5120
  s_add_u32 s34, s34, 81920
  s_mov_b32 s24, 0
  s_mov_b32 s72, s42
  s_and_b32 s73, s43, 0xffff
  s_mov_b32 s74, 1966080
  s_mov_b32 s75, 0x00020000
  s_lshl_b32 s8, s51, 8
  s_add_u32 s8, s8, s2
  s_mul_i32 s9, s8, 1366
  s_lshr_b32 s9, s9, 16
  s_mul_i32 s10, s9, 48
  s_sub_u32 s10, s8, s10
  s_mul_i32 s46, s10, 40960
  s_mul_i32 s11, s9, 160
  s_add_u32 s46, s46, s11
  s_mul_i32 s47, s8, 5120
  s_add_u32 s47, s47, 20971520
  s_cmp_lt_u32 s8, 384
  s_cselect_b32 s46, s46, 2147483632
  s_cselect_b32 s47, s47, 2147483632
  s_mov_b32 s23, s13
  s_mul_i32 s22, s23, 163840
  s_add_u32 s22, s22, s88
  s_mul_i32 s8, s24, 20480
  s_add_u32 m0, s8, s34
  s_nop 0
  buffer_load_dwordx4 v11, s[60:63], s22 offen offset:0 lds
  buffer_load_dwordx4 v12, s[60:63], s22 offen offset:1024 lds
  buffer_load_dwordx4 v13, s[60:63], s22 offen offset:2048 lds
  buffer_load_dwordx4 v14, s[60:63], s22 offen offset:3072 lds
  s_add_u32 m0, m0, 4096
  s_nop 0
  buffer_load_dwordx4 v15, s[60:63], s22 offen offset:0 lds
  s_add_u32 s24, s24, 1
  s_cmp_eq_u32 s24, 3
  s_cselect_b32 s24, 0, s24
  s_add_u32 s23, s23, 1
  s_add_u32 s22, s22, 163840
  s_cmp_eq_u32 s23, 5
  s_cselect_b32 s8, 819200, 0
  s_cselect_b32 s23, 0, s23
  s_sub_u32 s22, s22, s8
  buffer_load_dwordx4 v[156:159], v11, s[72:75], s46 offen offset:0
  buffer_load_dwordx4 v[160:163], v12, s[72:75], s46 offen offset:1024
  buffer_load_dwordx4 v[164:167], v13, s[72:75], s46 offen offset:2048
  buffer_load_dwordx4 v[168:171], v14, s[72:75], s46 offen offset:3072
  buffer_load_dwordx4 v[172:175], v15, s[72:75], s46 offen offset:0
  s_setprio 2
  v_min_u32 v226, 39, v0
  s_mul_i32 s8, s51, 40
  v_add_u32 v227, s8, v226
  v_lshrrev_b32 v228, 4, v227
  v_and_b32 v229, 7, v227
  v_lshl_add_u32 v228, v228, 3, v229
  s_mul_i32 s9, s4, 80
  v_add_u32 v228, s9, v228
  v_lshlrev_b32 v228, 1, v228
  global_load_ushort v220, v228, s[18:19]
  global_load_ushort v221, v228, s[20:21]
  global_load_ushort v222, v228, s[30:31]
  v_min_u32 v229, 59, v0
  v_mul_u32_u24 v231, 3277, v229
  v_lshrrev_b32 v231, 16, v231
  v_mul_u32_u24 v230, 20, v231
  v_sub_u32 v230, v229, v230
  s_mul_i32 s8, s51, 20
  v_add_u32 v230, s8, v230
  v_add_u32 v229, s9, v230
  v_lshlrev_b32 v229, 1, v229
  global_load_ushort v223, v229, s[18:19]
  global_load_ushort v224, v229, s[20:21]
  global_load_ushort v225, v229, s[30:31]
  s_waitcnt vmcnt(16) lgkmcnt(0)
  s_branch L_ln0
L_pre_c:
  v_and_b32 v234, 15, v0
  v_lshrrev_b32 v235, 4, v0
  s_lshl_b32 s8, s51, 4
  s_add_u32 s8, s8, s6
  v_add_u32 v5, s8, v234
  v_mul_u32_u24 v5, 1280, v5
  s_mul_i32 s9, s4, 160
  v_lshl_add_u32 v6, v235, 3, s9
  v_add_u32 v5, v5, v6
  buffer_load_dwordx2 v[164:165], v5, s[56:59], 0 offen offset:0
  buffer_load_dwordx2 v[166:167], v5, s[56:59], 0 offen offset:32
  buffer_load_dwordx2 v[168:169], v5, s[56:59], 0 offen offset:64
  buffer_load_dwordx2 v[170:171], v5, s[56:59], 0 offen offset:96
  buffer_load_dwordx2 v[172:173], v5, s[56:59], 0 offen offset:128
  s_mov_b32 s60, s44
  s_and_b32 s61, s45, 0xffff
  s_mov_b32 s62, 5242880
  s_mov_b32 s63, 0x00020000
  v_lshrrev_b32 v8, 1, v235
  v_lshlrev_b32 v8, 4, v8
  v_and_b32 v9, 1, v235
  v_lshl_add_u32 v8, v9, 2, v8
  v_lshrrev_b32 v9, 2, v234
  v_add_u32 v8, v8, v9
  v_and_b32 v10, 3, v0
  v_mul_u32_u24 v11, 160, v8
  v_lshl_add_u32 v236, v10, 3, v11
  v_add_u32 v236, 81920, v236
  s_lshl_b32 s8, s51, 4
  v_add_u32 v8, s8, v234
  v_and_b32 v9, 2, v8
  v_lshrrev_b32 v10, 1, v8
  v_and_b32 v10, 4, v10
  v_or_b32 v9, v9, v10
  v_xor_b32 v9, v9, v235
  v_lshlrev_b32 v9, 4, v9
  v_lshl_add_u32 v237, v8, 7, v9
  v_xor_b32 v238, 64, v237
  v_mov_b32 v8, 157056
  v_mov_b32 v12, 0
  v_mov_b32 v13, 0
  v_mov_b32 v14, 0
  v_mov_b32 v15, 0
  s_mov_b64 exec, 1
  ds_write_b128 v8, v[12:15]
  s_mov_b64 exec, -1
  s_mov_b32 s64, 0
  s_waitcnt vmcnt(5) lgkmcnt(0)
L_ln0:
  s_mul_i32 s7, s7, 1664525
  s_add_u32 s7, s7, 1013904223
  v_mov_b32 v140, 0
  v_mov_b32 v141, 0
  v_mov_b32 v142, 0
  v_mov_b32 v143, 0
  v_dot2c_f32_bf16 v140, s14, v100
  v_dot2c_f32_bf16 v141, s14, v101
  v_dot2c_f32_bf16 v142, s14, v102
  v_dot2c_f32_bf16 v143, s14, v103
  v_dot2c_f32_bf16 v140, s14, v104
  v_dot2c_f32_bf16 v141, s14, v105
  v_dot2c_f32_bf16 v142, s14, v106
  v_dot2c_f32_bf16 v143, s14, v107
  v_dot2c_f32_bf16 v140, s14, v108
  v_dot2c_f32_bf16 v141, s14, v109
  v_dot2c_f32_bf16 v142, s14, v110
  v_dot2c_f32_bf16 v143, s14, v111
  v_dot2c_f32_bf16 v140, s14, v112
  v_dot2c_f32_bf16 v141, s14, v113
  v_dot2c_f32_bf16 v142, s14, v114
  v_dot2c_f32_bf16 v143, s14, v115
  v_dot2c_f32_bf16 v140, s14, v116
  v_dot2c_f32_bf16 v141, s14, v117
  v_dot2c_f32_bf16 v142, s14, v118
  v_dot2c_f32_bf16 v143, s14, v119
  v_dot2c_f32_bf16 v140, s14, v120
  v_dot2c_f32_bf16 v141, s14, v121
  v_dot2c_f32_bf16 v142, s14, v122
  v_dot2c_f32_bf16 v143, s14, v123
  v_dot2c_f32_bf16 v140, s14, v124
  v_dot2c_f32_bf16 v141, s14, v125
  v_dot2c_f32_bf16 v142, s14, v126
  v_dot2c_f32_bf16 v143, s14, v127
  v_dot2c_f32_bf16 v140, s14, v128
  v_dot2c_f32_bf16 v141, s14, v129
  v_dot2c_f32_bf16 v142, s14, v130
  v_dot2c_f32_bf16 v143, s14, v131
  v_dot2c_f32_bf16 v140, s14, v132
  v_dot2c_f32_bf16 v141, s14, v133
  v_dot2c_f32_bf16 v142, s14, v134
  v_dot2c_f32_bf16 v143, s14, v135
  v_dot2c_f32_bf16 v140, s14, v136
  v_dot2c_f32_bf16 v141, s14, v137
  v_dot2c_f32_bf16 v142, s14, v138
  v_dot2c_f32_bf16 v143, s14, v139
  v_and_b32 v153, 2, v2
  v_lshrrev_b32 v154, 1, v2
  v_and_b32 v154, 4, v154
  v_or_b32 v153, v153, v154
  v_xor_b32 v153, v153, v3
  v_lshlrev_b32 v153, 4, v153
  v_lshl_add_u32 v153, v2, 7, v153
  v_add_f32 v140, v140, v141
  v_add_f32 v142, v142, v143
  v_add_f32 v140, v140, v142
  s_nop 1
  v_add_f32_dpp v140, v140, v140 quad_perm:[1,0,3,2] row_mask:0xf bank_mask:0xf
  s_nop 1
  v_add_f32_dpp v140, v140, v140 quad_perm:[2,3,0,1] row_mask:0xf bank_mask:0xf
  s_nop 1
  v_add_f32_dpp v140, v140, v140 row_half_mirror row_mask:0xf bank_mask:0xf
  v_mul_f32 v152, 0xbacccccd, v140
  s_lshl_b32 s8, s13, 1
  s_add_u32 s12, s4, 10
  s_sub_u32 s12, s12, s8
  s_cmp_ge_u32 s12, 10
  s_cselect_b32 s8, 10, 0
  s_sub_u32 s12, s12, s8
  v_mov_b32 v140, 0
  v_mov_b32 v141, 0
  v_mov_b32 v142, 0
  v_mov_b32 v143, 0
  v_dot2_f32_bf16 v144, v100, s15, v152
  v_dot2_f32_bf16 v145, v100, s50, v152
  v_dot2_f32_bf16 v146, v101, s15, v152
  v_dot2_f32_bf16 v147, v101, s50, v152
  v_dot2_f32_bf16 v148, v102, s15, v152
  v_dot2_f32_bf16 v149, v102, s50, v152
  v_dot2_f32_bf16 v150, v103, s15, v152
  v_dot2_f32_bf16 v151, v103, s50, v152
  s_lshl_b32 s8, s12, 13
  v_add_u32 v154, s8, v153
  s_add_u32 s12, s12, 1
  v_cvt_pk_bf16_f32 v100, v144, v145
  v_cvt_pk_bf16_f32 v101, v146, v147
  v_cvt_pk_bf16_f32 v102, v148, v149
  v_cvt_pk_bf16_f32 v103, v150, v151
  s_cmp_eq_u32 s12, 10
  s_cselect_b32 s12, 0, s12
  ds_write_b128 v154, v[100:103]
  v_dot2c_f32_bf16 v140, v100, v100
  v_dot2c_f32_bf16 v141, v101, v101
  v_dot2c_f32_bf16 v142, v102, v102
  v_dot2c_f32_bf16 v143, v103, v103
  v_dot2_f32_bf16 v144, v104, s15, v152
  v_dot2_f32_bf16 v145, v104, s50, v152
  v_dot2_f32_bf16 v146, v105, s15, v152
  v_dot2_f32_bf16 v147, v105, s50, v152
  v_dot2_f32_bf16 v148, v106, s15, v152
  v_dot2_f32_bf16 v149, v106, s50, v152
  v_dot2_f32_bf16 v150, v107, s15, v152
  v_dot2_f32_bf16 v151, v107, s50, v152
  s_lshl_b32 s8, s12, 13
  v_add_u32 v154, s8, v153
  s_add_u32 s12, s12, 1
  v_cvt_pk_bf16_f32 v104, v144, v145
  v_cvt_pk_bf16_f32 v105, v146, v147
  v_cvt_pk_bf16_f32 v106, v148, v149
  v_cvt_pk_bf16_f32 v107, v150, v151
  s_cmp_eq_u32 s12, 10
  s_cselect_b32 s12, 0, s12
  ds_write_b128 v154, v[104:107]
  v_dot2c_f32_bf16 v140, v104, v104
  v_dot2c_f32_bf16 v141, v105, v105
  v_dot2c_f32_bf16 v142, v106, v106
  v_dot2c_f32_bf16 v143, v107, v107
  v_dot2_f32_bf16 v144, v108, s15, v152
  v_dot2_f32_bf16 v145, v108, s50, v152
  v_dot2_f32_bf16 v146, v109, s15, v152
  v_dot2_f32_bf16 v147, v109, s50, v152
  v_dot2_f32_bf16 v148, v110, s15, v152
  v_dot2_f32_bf16 v149, v110, s50, v152
  v_dot2_f32_bf16 v150, v111, s15, v152
  v_dot2_f32_bf16 v151, v111, s50, v152
  s_lshl_b32 s8, s12, 13
  v_add_u32 v154, s8, v153
  s_add_u32 s12, s12, 1
  v_cvt_pk_bf16_f32 v108, v144, v145
  v_cvt_pk_bf16_f32 v109, v146, v147
  v_cvt_pk_bf16_f32 v110, v148, v149
  v_cvt_pk_bf16_f32 v111, v150, v151
  s_cmp_eq_u32 s12, 10
  s_cselect_b32 s12, 0, s12
  ds_write_b128 v154, v[108:111]
  v_dot2c_f32_bf16 v140, v108, v108
  v_dot2c_f32_bf16 v141, v109, v109
  v_dot2c_f32_bf16 v142, v110, v110
  v_dot2c_f32_bf16 v143, v111, v111
  v_dot2_f32_bf16 v144, v112, s15, v152
  v_dot2_f32_bf16 v145, v112, s50, v152
  v_dot2_f32_bf16 v146, v113, s15, v152
  v_dot2_f32_bf16 v147, v113, s50, v152
  v_dot2_f32_bf16 v148, v114, s15, v152
  v_dot2_f32_bf16 v149, v114, s50, v152
  v_dot2_f32_bf16 v150, v115, s15, v152
  v_dot2_f32_bf16 v151, v115, s50, v152
  s_lshl_b32 s8, s12, 13
  v_add_u32 v154, s8, v153
  s_add_u32 s12, s12, 1
  v_cvt_pk_bf16_f32 v112, v144, v145
  v_cvt_pk_bf16_f32 v113, v146, v147
  v_cvt_pk_bf16_f32 v114, v148, v149
  v_cvt_pk_bf16_f32 v115, v150, v151
  s_cmp_eq_u32 s12, 10
  s_cselect_b32 s12, 0, s12
  ds_write_b128 v154, v[112:115]
  v_dot2c_f32_bf16 v140, v112, v112
  v_dot2c_f32_bf16 v141, v113, v113
  v_dot2c_f32_bf16 v142, v114, v114
  v_dot2c_f32_bf16 v143, v115, v115
  v_dot2_f32_bf16 v144, v116, s15, v152
  v_dot2_f32_bf16 v145, v116, s50, v152
  v_dot2_f32_bf16 v146, v117, s15, v152
  v_dot2_f32_bf16 v147, v117, s50, v152
  v_dot2_f32_bf16 v148, v118, s15, v152
  v_dot2_f32_bf16 v149, v118, s50, v152
  v_dot2_f32_bf16 v150, v119, s15, v152
  v_dot2_f32_bf16 v151, v119, s50, v152
  s_lshl_b32 s8, s12, 13
  v_add_u32 v154, s8, v153
  s_add_u32 s12, s12, 1
  v_cvt_pk_bf16_f32 v116, v144, v145
  v_cvt_pk_bf16_f32 v117, v146, v147
  v_cvt_pk_bf16_f32 v118, v148, v149
  v_cvt_pk_bf16_f32 v119, v150, v151
  s_cmp_eq_u32 s12, 10
  s_cselect_b32 s12, 0, s12
  ds_write_b128 v154, v[116:119]
  v_dot2c_f32_bf16 v140, v116, v116
  v_dot2c_f32_bf16 v141, v117, v117
  v_dot2c_f32_bf16 v142, v118, v118
  v_dot2c_f32_bf16 v143, v119, v119
  v_dot2_f32_bf16 v144, v120, s15, v152
  v_dot2_f32_bf16 v145, v120, s50, v152
  v_dot2_f32_bf16 v146, v121, s15, v152
  v_dot2_f32_bf16 v147, v121, s50, v152
  v_dot2_f32_bf16 v148, v122, s15, v152
  v_dot2_f32_bf16 v149, v122, s50, v152
  v_dot2_f32_bf16 v150, v123, s15, v152
  v_dot2_f32_bf16 v151, v123, s50, v152
  s_lshl_b32 s8, s12, 13
  v_add_u32 v154, s8, v153
  s_add_u32 s12, s12, 1
  v_cvt_pk_bf16_f32 v120, v144, v145
  v_cvt_pk_bf16_f32 v121, v146, v147
  v_cvt_pk_bf16_f32 v122, v148, v149
  v_cvt_pk_bf16_f32 v123, v150, v151
  s_cmp_eq_u32 s12, 10
  s_cselect_b32 s12, 0, s12
  ds_write_b128 v154, v[120:123]
  v_dot2c_f32_bf16 v140, v120, v120
  v_dot2c_f32_bf16 v141, v121, v121
  v_dot2c_f32_bf16 v142, v122, v122
  v_dot2c_f32_bf16 v143, v123, v123
  v_dot2_f32_bf16 v144, v124, s15, v152
  v_dot2_f32_bf16 v145, v124, s50, v152
  v_dot2_f32_bf16 v146, v125, s15, v152
  v_dot2_f32_bf16 v147, v125, s50, v152
  v_dot2_f32_bf16 v148, v126, s15, v152
  v_dot2_f32_bf16 v149, v126, s50, v152
  v_dot2_f32_bf16 v150, v127, s15, v152
  v_dot2_f32_bf16 v151, v127, s50, v152
  s_lshl_b32 s8, s12, 13
  v_add_u32 v154, s8, v153
  s_add_u32 s12, s12, 1
  v_cvt_pk_bf16_f32 v124, v144, v145
  v_cvt_pk_bf16_f32 v125, v146, v147
  v_cvt_pk_bf16_f32 v126, v148, v149
  v_cvt_pk_bf16_f32 v127, v150, v151
  s_cmp_eq_u32 s12, 10
  s_cselect_b32 s12, 0, s12
  ds_write_b128 v154, v[124:127]
  v_dot2c_f32_bf16 v140, v124, v124
  v_dot2c_f32_bf16 v141, v125, v125
  v_dot2c_f32_bf16 v142, v126, v126
  v_dot2c_f32_bf16 v143, v127, v127
  v_dot2_f32_bf16 v144, v128, s15, v152
  v_dot2_f32_bf16 v145, v128, s50, v152
  v_dot2_f32_bf16 v146, v129, s15, v152
  v_dot2_f32_bf16 v147, v129, s50, v152
  v_dot2_f32_bf16 v148, v130, s15, v152
  v_dot2_f32_bf16 v149, v130, s50, v152
  v_dot2_f32_bf16 v150, v131, s15, v152
  v_dot2_f32_bf16 v151, v131, s50, v152
  s_lshl_b32 s8, s12, 13
  v_add_u32 v154, s8, v153
  s_add_u32 s12, s12, 1
  v_cvt_pk_bf16_f32 v128, v144, v145
  v_cvt_pk_bf16_f32 v129, v146, v147
  v_cvt_pk_bf16_f32 v130, v148, v149
  v_cvt_pk_bf16_f32 v131, v150, v151
  s_cmp_eq_u32 s12, 10
  s_cselect_b32 s12, 0, s12
  ds_write_b128 v154, v[128:131]
  v_dot2c_f32_bf16 v140, v128, v128
  v_dot2c_f32_bf16 v141, v129, v129
  v_dot2c_f32_bf16 v142, v130, v130
  v_dot2c_f32_bf16 v143, v131, v131
  v_dot2_f32_bf16 v144, v132, s15, v152
  v_dot2_f32_bf16 v145, v132, s50, v152
  v_dot2_f32_bf16 v146, v133, s15, v152
  v_dot2_f32_bf16 v147, v133, s50, v152
  v_dot2_f32_bf16 v148, v134, s15, v152
  v_dot2_f32_bf16 v149, v134, s50, v152
  v_dot2_f32_bf16 v150, v135, s15, v152
  v_dot2_f32_bf16 v151, v135, s50, v152
  s_lshl_b32 s8, s12, 13
  v_add_u32 v154, s8, v153
  s_add_u32 s12, s12, 1
  v_cvt_pk_bf16_f32 v132, v144, v145
  v_cvt_pk_bf16_f32 v133, v146, v147
  v_cvt_pk_bf16_f32 v134, v148, v149
  v_cvt_pk_bf16_f32 v135, v150, v151
  s_cmp_eq_u32 s12, 10
  s_cselect_b32 s12, 0, s12
  ds_write_b128 v154, v[132:135]
  v_dot2c_f32_bf16 v140, v132, v132
  v_dot2c_f32_bf16 v141, v133, v133
  v_dot2c_f32_bf16 v142, v134, v134
  v_dot2c_f32_bf16 v143, v135, v135
  v_dot2_f32_bf16 v144, v136, s15, v152
  v_dot2_f32_bf16 v145, v136, s50, v152
  v_dot2_f32_bf16 v146, v137, s15, v152
  v_dot2_f32_bf16 v147, v137, s50, v152
  v_dot2_f32_bf16 v148, v138, s15, v152
  v_dot2_f32_bf16 v149, v138, s50, v152
  v_dot2_f32_bf16 v150, v139, s15, v152
  v_dot2_f32_bf16 v151, v139, s50, v152
  s_lshl_b32 s8, s12, 13
  v_add_u32 v154, s8, v153
  s_add_u32 s12, s12, 1
  v_cvt_pk_bf16_f32 v136, v144, v145
  v_cvt_pk_bf16_f32 v137, v146, v147
  v_cvt_pk_bf16_f32 v138, v148, v149
  v_cvt_pk_bf16_f32 v139, v150, v151
  s_cmp_eq_u32 s12, 10
  s_cselect_b32 s12, 0, s12
  ds_write_b128 v154, v[136:139]
  v_dot2c_f32_bf16 v140, v136, v136
  v_dot2c_f32_bf16 v141, v137, v137
  v_dot2c_f32_bf16 v142, v138, v138
  v_dot2c_f32_bf16 v143, v139, v139
  s_nop 0
  v_add_f32 v140, v140, v141
  s_nop 0
  v_add_f32 v142, v142, v143
  v_add_f32 v140, v140, v142
  s_nop 1
  v_add_f32_dpp v140, v140, v140 quad_perm:[1,0,3,2] row_mask:0xf bank_mask:0xf
  s_nop 1
  v_add_f32_dpp v140, v140, v140 quad_perm:[2,3,0,1] row_mask:0xf bank_mask:0xf
  s_nop 1
  v_add_f32_dpp v140, v140, v140 row_half_mirror row_mask:0xf bank_mask:0xf
  v_mul_f32 v140, 0x3acccccd, v140
  v_add_f32 v141, 0x3727c5ac, v140
  v_rsq_f32 v141, v141
  s_nop 0
  v_mul_f32 v142, v141, v141
  v_mul_f32 v142, v142, v140
  v_add_f32 v142, 0x3727c5ac, v142
  v_rsq_f32 v142, v142
  s_nop 0
  v_mul_f32 v142, v142, v141
  v_sub_f32 v152, 0, v152
  v_lshlrev_b32 v147, 2, v2
  v_add_u32 v147, 155648, v147
  v_cmp_eq_u32 vcc, 0, v3
  s_nop 3
  s_and_saveexec_b64 s[94:95], vcc
  ds_write_b32 v147, v152 offset:0
  ds_write_b32 v147, v141 offset:256
  ds_write_b32 v147, v142 offset:512
  s_mov_b64 exec, s[94:95]
  s_cmp_lt_u32 s3, 4
  s_cbranch_scc0 L_loader
  s_setprio 1
  s_mov_b32 s66, 0xffff0000
  s_movk_i32 s71, 160
  s_lshr_b32 s8, s4, 1
  s_lshr_b32 s9, s8, 1
  s_add_u32 s9, s9, 1
  s_and_b32 s8, s8, 1
  s_sub_u32 s10, 0, s9
  s_cmp_eq_u32 s8, 0
  s_cselect_b32 s68, s9, s10
  s_lshl_b32 s8, s51, 4
  s_add_u32 s8, s8, s6
  s_add_u32 s69, s8, s68
  s_and_b32 s67, s2, 7
  s_mul_i32 s67, s67, 327680
  s_mov_b32 s11, 0
  s_call_b64 s[30:31], L_tileaddr
  v_mov_b32 v188, v9
  s_mov_b32 s11, 64
  s_call_b64 s[30:31], L_tileaddr
  v_mov_b32 v189, v9
  s_mov_b32 s11, 128
  s_call_b64 s[30:31], L_tileaddr
  v_mov_b32 v190, v9
  s_lshl_b32 s69, s51, 4
  s_add_u32 s69, s69, s6
  s_mov_b32 s11, 0
  s_call_b64 s[30:31], L_tileaddr
  v_mov_b32 v192, v9
  s_mov_b32 s11, 64
  s_call_b64 s[30:31], L_tileaddr
  v_mov_b32 v193, v9
  s_mov_b32 s11, 128
  s_call_b64 s[30:31], L_tileaddr
  v_mov_b32 v99, v9
  v_mov_b32 v76, 0
  v_mov_b32 v77, 0
  v_mov_b32 v78, 0
  v_mov_b32 v79, 0
  v_mov_b32 v80, 0
  v_mov_b32 v81, 0
  v_mov_b32 v82, 0
  v_mov_b32 v83, 0
  v_mov_b32 v84, 0
  v_mov_b32 v85, 0
  v_mov_b32 v86, 0
  v_mov_b32 v87, 0
  v_mov_b32 v88, 0
  v_mov_b32 v89, 0
  v_mov_b32 v90, 0
  v_mov_b32 v91, 0
  v_mov_b32 v92, 0
  v_mov_b32 v93, 0
  v_mov_b32 v94, 0
  v_mov_b32 v95, 0
  v_mov_b32 v132, 0
  v_mov_b32 v133, 0
  v_mov_b32 v134, 0
  v_mov_b32 v135, 0
  v_mov_b32 v136, 0
  v_mov_b32 v137, 0
  v_mov_b32 v138, 0
  v_mov_b32 v139, 0
  v_mov_b32 v140, 0
  v_mov_b32 v141, 0
  v_mov_b32 v142, 0
  v_mov_b32 v143, 0
  v_mov_b32 v144, 0
  v_mov_b32 v145, 0
  v_mov_b32 v146, 0
  v_mov_b32 v147, 0
  v_mov_b32 v148, 0
  v_mov_b32 v149, 0
  v_mov_b32 v150, 0
  v_mov_b32 v151, 0
  v_mov_b32 v152, 0
  v_mov_b32 v153, 0
  v_mov_b32 v154, 0
  v_mov_b32 v155, 0
  s_mov_b32 s65, 0
  s_mul_i32 s8, s64, 20480
  v_add_u32 v254, s8, v236
  v_add_u32 v255, s65, v237
  v_add_u32 v15, s65, v238
  s_waitcnt lgkmcnt(0)
  s_mov_b32 s101, 5
  s_call_b64 s[30:31], L_gemm80
  v_mfma_f32_16x16x32_bf16 v[76:79], v[136:139], v[132:135], v[76:79]
  v_mfma_f32_16x16x32_bf16 v[80:83], v[140:143], v[132:135], v[80:83]
  v_mfma_f32_16x16x32_bf16 v[84:87], v[144:147], v[132:135], v[84:87]
  v_mfma_f32_16x16x32_bf16 v[88:91], v[148:151], v[132:135], v[88:91]
  v_mfma_f32_16x16x32_bf16 v[92:95], v[152:155], v[132:135], v[92:95]
  s_barrier
  s_lshl_b32 s8, s51, 6
  v_lshl_add_u32 v2, v234, 2, s8
  v_add_u32 v2, 155648, v2
  ds_read_b32 v245, v2 offset:0
  ds_read_b32 v246, v2 offset:256
  ds_read_b32 v247, v2 offset:512
  v_mov_b32 v4, 157068
  ds_read_b32 v3, v4
  v_mov_b32 v104, 0xbdd2d3e8
  v_mov_b32 v105, 0xbdd2d3e8
  v_mov_b32 v106, 0xc0135761
  v_mov_b32 v107, 0xc0135761
  v_mov_b32 v108, 1.0
  v_mov_b32 v109, 1.0
  s_waitcnt lgkmcnt(0)
  v_readfirstlane_b32 s100, v3
  v_mov_b32 v110, v247
  v_mov_b32 v111, v247
  v_pk_mul_f32 v[76:77], v[76:77], v[110:111]
  v_pk_mul_f32 v[78:79], v[78:79], v[110:111]
  v_pk_mul_f32 v[80:81], v[80:81], v[110:111]
  v_pk_mul_f32 v[82:83], v[82:83], v[110:111]
  v_pk_mul_f32 v[84:85], v[84:85], v[110:111]
  v_pk_mul_f32 v[86:87], v[86:87], v[110:111]
  v_pk_mul_f32 v[88:89], v[88:89], v[110:111]
  v_pk_mul_f32 v[90:91], v[90:91], v[110:111]
  v_pk_mul_f32 v[92:93], v[92:93], v[110:111]
  v_pk_mul_f32 v[94:95], v[94:95], v[110:111]
  v_pk_mul_f32 v[100:101], v[76:77], v[76:77]
  v_pk_mul_f32 v[102:103], v[78:79], v[78:79]
  v_pk_fma_f32 v[100:101], v[100:101], v[104:105], v[106:107]
  v_pk_fma_f32 v[102:103], v[102:103], v[104:105], v[106:107]
  v_pk_mul_f32 v[100:101], v[100:101], v[76:77]
  v_pk_mul_f32 v[102:103], v[102:103], v[78:79]
  v_exp_f32 v100, v100
  v_exp_f32 v101, v101
  v_exp_f32 v102, v102
  v_exp_f32 v103, v103
  v_pk_add_f32 v[100:101], v[100:101], v[108:109]
  v_pk_add_f32 v[102:103], v[102:103], v[108:109]
  v_rcp_f32 v100, v100
  v_rcp_f32 v101, v101
  v_rcp_f32 v102, v102
  v_rcp_f32 v103, v103
  v_pk_mul_f32 v[76:77], v[76:77], v[100:101]
  v_pk_mul_f32 v[78:79], v[78:79], v[102:103]
  v_pk_mul_f32 v[100:101], v[80:81], v[80:81]
  v_pk_mul_f32 v[102:103], v[82:83], v[82:83]
  v_pk_fma_f32 v[100:101], v[100:101], v[104:105], v[106:107]
  v_pk_fma_f32 v[102:103], v[102:103], v[104:105], v[106:107]
  v_pk_mul_f32 v[100:101], v[100:101], v[80:81]
  v_pk_mul_f32 v[102:103], v[102:103], v[82:83]
  v_exp_f32 v100, v100
  v_exp_f32 v101, v101
  v_exp_f32 v102, v102
  v_exp_f32 v103, v103
  v_pk_add_f32 v[100:101], v[100:101], v[108:109]
  v_pk_add_f32 v[102:103], v[102:103], v[108:109]
  v_rcp_f32 v100, v100
  v_rcp_f32 v101, v101
  v_rcp_f32 v102, v102
  v_rcp_f32 v103, v103
  v_pk_mul_f32 v[80:81], v[80:81], v[100:101]
  v_pk_mul_f32 v[82:83], v[82:83], v[102:103]
  v_pk_mul_f32 v[100:101], v[84:85], v[84:85]
  v_pk_mul_f32 v[102:103], v[86:87], v[86:87]
  v_pk_fma_f32 v[100:101], v[100:101], v[104:105], v[106:107]
  v_pk_fma_f32 v[102:103], v[102:103], v[104:105], v[106:107]
  v_pk_mul_f32 v[100:101], v[100:101], v[84:85]
  v_pk_mul_f32 v[102:103], v[102:103], v[86:87]
  v_exp_f32 v100, v100
  v_exp_f32 v101, v101
  v_exp_f32 v102, v102
  v_exp_f32 v103, v103
  v_pk_add_f32 v[100:101], v[100:101], v[108:109]
  v_pk_add_f32 v[102:103], v[102:103], v[108:109]
  v_rcp_f32 v100, v100
  v_rcp_f32 v101, v101
  v_rcp_f32 v102, v102
  v_rcp_f32 v103, v103
  v_pk_mul_f32 v[84:85], v[84:85], v[100:101]
  v_pk_mul_f32 v[86:87], v[86:87], v[102:103]
  v_pk_mul_f32 v[100:101], v[88:89], v[88:89]
  v_pk_mul_f32 v[102:103], v[90:91], v[90:91]
  v_pk_fma_f32 v[100:101], v[100:101], v[104:105], v[106:107]
  v_pk_fma_f32 v[102:103], v[102:103], v[104:105], v[106:107]
  v_pk_mul_f32 v[100:101], v[100:101], v[88:89]
  v_pk_mul_f32 v[102:103], v[102:103], v[90:91]
  v_exp_f32 v100, v100
  v_exp_f32 v101, v101
  v_exp_f32 v102, v102
  v_exp_f32 v103, v103
  v_pk_add_f32 v[100:101], v[100:101], v[108:109]
  v_pk_add_f32 v[102:103], v[102:103], v[108:109]
  v_rcp_f32 v100, v100
  v_rcp_f32 v101, v101
  v_rcp_f32 v102, v102
  v_rcp_f32 v103, v103
  v_pk_mul_f32 v[88:89], v[88:89], v[100:101]
  v_pk_mul_f32 v[90:91], v[90:91], v[102:103]
  v_pk_mul_f32 v[100:101], v[92:93], v[92:93]
  v_pk_mul_f32 v[102:103], v[94:95], v[94:95]
  v_pk_fma_f32 v[100:101], v[100:101], v[104:105], v[106:107]
  v_pk_fma_f32 v[102:103], v[102:103], v[104:105], v[106:107]
  v_pk_mul_f32 v[100:101], v[100:101], v[92:93]
  v_pk_mul_f32 v[102:103], v[102:103], v[94:95]
  v_exp_f32 v100, v100
  v_exp_f32 v101, v101
  v_exp_f32 v102, v102
  v_exp_f32 v103, v103
  v_pk_add_f32 v[100:101], v[100:101], v[108:109]
  v_pk_add_f32 v[102:103], v[102:103], v[108:109]
  v_rcp_f32 v100, v100
  v_rcp_f32 v101, v101
  v_rcp_f32 v102, v102
  v_rcp_f32 v103, v103
  v_pk_mul_f32 v[92:93], v[92:93], v[100:101]
  v_pk_mul_f32 v[94:95], v[94:95], v[102:103]
  v_cvt_pk_bf16_f32 v112, v76, v77
  v_cvt_pk_bf16_f32 v113, v78, v79
  v_cvt_pk_bf16_f32 v114, v80, v81
  v_cvt_pk_bf16_f32 v115, v82, v83
  v_cvt_pk_bf16_f32 v116, v84, v85
  v_cvt_pk_bf16_f32 v117, v86, v87
  v_cvt_pk_bf16_f32 v118, v88, v89
  v_cvt_pk_bf16_f32 v119, v90, v91
  v_cvt_pk_bf16_f32 v120, v92, v93
  v_cvt_pk_bf16_f32 v121, v94, v95
  s_and_b32 s9, s51, 1
  s_mul_i32 s9, s9, 2560
  s_cmp_lt_u32 s51, 2
  s_cselect_b32 s10, 158208, 0
  s_cselect_b32 s11, 0, 1
  s_mul_i32 s11, s11, 148480
  s_add_u32 s9, s9, s10
  s_add_u32 s9, s9, s11
  v_mul_u32_u24 v2, 160, v234
  v_lshl_add_u32 v2, v235, 3, v2
  v_add_u32 v2, s9, v2
  v_lshlrev_b32 v9, 4, v0
  v_add_u32 v9, s9, v9
  ds_write_b64 v2, v[112:113] offset:0
  ds_write_b64 v2, v[114:115] offset:32
  ds_write_b64 v2, v[116:117] offset:64
  ds_write_b64 v2, v[118:119] offset:96
  ds_write_b64 v2, v[120:121] offset:128
  s_waitcnt lgkmcnt(0)
  ds_read_b128 v[140:143], v9 offset:0
  ds_read_b128 v[144:147], v9 offset:1024
  ds_read_b128 v[148:151], v9 offset:2048
  s_mov_b32 s9, 1048576
  s_waitcnt lgkmcnt(0)
  v_subrev_u32 v3, s67, v188
  v_cmp_gt_u32 vcc, 327680, v3
  s_cmp_eq_u32 s100, 1
  s_nop 2
  s_cselect_b64 vcc, vcc, 0
  s_mov_b64 exec, vcc
  buffer_store_dwordx4 v[140:143], v188, s[52:55], s9 offen
  s_not_b64 exec, vcc
  buffer_store_dwordx4 v[140:143], v188, s[52:55], s9 offen sc1
  s_mov_b64 exec, -1
  v_subrev_u32 v3, s67, v189
  v_cmp_gt_u32 vcc, 327680, v3
  s_cmp_eq_u32 s100, 1
  s_nop 2
  s_cselect_b64 vcc, vcc, 0
  s_mov_b64 exec, vcc
  buffer_store_dwordx4 v[144:147], v189, s[52:55], s9 offen
  s_not_b64 exec, vcc
  buffer_store_dwordx4 v[144:147], v189, s[52:55], s9 offen sc1
  s_mov_b64 exec, -1
  v_subrev_u32 v3, s67, v190
  v_cmp_gt_u32 vcc, 327680, v3
  s_cmp_eq_u32 s100, 1
  s_nop 2
  s_cselect_b64 vcc, vcc, 0
  s_mov_b64 exec, vcc
  buffer_store_dwordx4 v[148:151], v190, s[52:55], s9 offen
  s_not_b64 exec, vcc
  buffer_store_dwordx4 v[148:151], v190, s[52:55], s9 offen sc1
  s_mov_b64 exec, -1
  s_cmp_lg_u32 s51, 0
  s_cbranch_scc1 L_nozero
  s_cmp_gt_i32 s68, 0
  s_cselect_b32 s8, 0, 31
  s_cmp_lg_u32 s5, s8
  s_cbranch_scc1 L_nozero
  s_add_u32 s69, s68, 2048
  s_cmp_gt_i32 s68, 0
  s_cselect_b32 s69, 0, s69
  s_abs_i32 s12, s68
  s_mul_i32 s12, s12, 10
  s_mov_b32 s71, s12
  s_mov_b32 s11, 0
  s_call_b64 s[30:31], L_tileaddr
  v_mov_b32 v152, v9
  v_mov_b32 v140, 0
  v_mov_b32 v141, 0
  v_mov_b32 v142, 0
  v_mov_b32 v143, 0
  s_mov_b32 s9, 1048576
  buffer_store_dwordx4 v[140:143], v152, s[52:55], s9 offen sc1
L_nozero:
  s_cmp_eq_u32 s51, 1
  s_cselect_b32 s98, s40, s38
  s_cselect_b32 s99, s41, s39
  s_cmp_eq_u32 s51, 2
  s_cselect_b32 s98, s26, s98
  s_cselect_b32 s99, s27, s99
  s_cmp_eq_u32 s51, 3
  s_cselect_b32 s98, s28, s98
  s_cselect_b32 s99, s29, s99
  s_cmp_eq_u32 s51, 1
  s_mov_b32 s11, 3200
  s_cselect_b32 s11, 7680, s11
  s_cselect_b32 s96, -1, 0x1ffffff
  s_cselect_b32 s97, 0xfffffff, 0
  s_mul_i32 s11, s2, s11
  v_lshlrev_b32 v5, 7, v0
  v_add_u32 v5, s11, v5
  s_mov_b64 exec, s[96:97]
  global_load_dword v97, v5, s[98:99]
  s_mov_b64 exec, -1
  s_lshr_b32 s8, s51, 1
  s_lshl_b32 s8, s8, 5
  v_lshrrev_b32 v2, 2, v234
  v_lshlrev_b32 v2, 3, v2
  v_and_b32 v3, 3, v234
  v_add3_u32 v2, v2, v3, s8
  v_and_b32 v3, 6, v234
  v_xor_b32 v3, v3, v235
  v_lshlrev_b32 v3, 4, v3
  v_lshl_add_u32 v239, v2, 7, v3
  v_xor_b32 v240, 64, v239
  s_and_b32 s9, s51, 1
  s_mul_i32 s9, s9, 40
  v_and_b32 v2, 7, v234
  v_add_u32 v2, s9, v2
  v_lshl_add_u32 v2, v2, 7, v3
  v_lshrrev_b32 v4, 3, v234
  v_mul_u32_u24 v4, 10240, v4
  v_add_u32 v2, v2, v4
  v_add_u32 v243, 81920, v2
  v_mov_b32 v16, 0
  v_mov_b32 v17, 0
  v_mov_b32 v18, 0
  v_mov_b32 v19, 0
  v_mov_b32 v20, 0
  v_mov_b32 v21, 0
  v_mov_b32 v22, 0
  v_mov_b32 v23, 0
  v_mov_b32 v24, 0
  v_mov_b32 v25, 0
  v_mov_b32 v26, 0
  v_mov_b32 v27, 0
  v_mov_b32 v28, 0
  v_mov_b32 v29, 0
  v_mov_b32 v30, 0
  v_mov_b32 v31, 0
  v_mov_b32 v32, 0
  v_mov_b32 v33, 0
  v_mov_b32 v34, 0
  v_mov_b32 v35, 0
  v_mov_b32 v36, 0
  v_mov_b32 v37, 0
  v_mov_b32 v38, 0
  v_mov_b32 v39, 0
  v_mov_b32 v40, 0
  v_mov_b32 v41, 0
  v_mov_b32 v42, 0
  v_mov_b32 v43, 0
  v_mov_b32 v44, 0
  v_mov_b32 v45, 0
  v_mov_b32 v46, 0
  v_mov_b32 v47, 0
  v_mov_b32 v48, 0
  v_mov_b32 v49, 0
  v_mov_b32 v50, 0
  v_mov_b32 v51, 0
  v_mov_b32 v52, 0
  v_mov_b32 v53, 0
  v_mov_b32 v54, 0
  v_mov_b32 v55, 0
  v_mov_b32 v132, 0
  v_mov_b32 v133, 0
  v_mov_b32 v134, 0
  v_mov_b32 v135, 0
  v_mov_b32 v136, 0
  v_mov_b32 v137, 0
  v_mov_b32 v138, 0
  v_mov_b32 v139, 0
  v_mov_b32 v140, 0
  v_mov_b32 v141, 0
  v_mov_b32 v142, 0
  v_mov_b32 v143, 0
  v_mov_b32 v144, 0
  v_mov_b32 v145, 0
  v_mov_b32 v146, 0
  v_mov_b32 v147, 0
  v_mov_b32 v148, 0
  v_mov_b32 v149, 0
  v_mov_b32 v150, 0
  v_mov_b32 v151, 0
  v_mov_b32 v152, 0
  v_mov_b32 v153, 0
  v_mov_b32 v154, 0
  v_mov_b32 v155, 0
  v_mov_b32 v156, 0
  v_mov_b32 v157, 0
  v_mov_b32 v158, 0
  v_mov_b32 v159, 0
  s_mul_i32 s8, s64, 20480
  v_add_u32 v241, s8, v243
  v_xor_b32 v242, 64, v241
  s_mul_i32 s8, s4, 10
  s_lshr_b32 s8, s8, 3
  s_lshl_b32 s8, s8, 13
  s_mul_i32 s9, s5, 81920
  s_add_u32 s8, s8, s9
  s_add_u32 s8, s8, 4194304
  s_mul_i32 s9, s51, 3
  v_add_u32 v98, s9, v0
  v_lshlrev_b32 v98, 7, v98
  v_add_u32 v98, s8, v98
  v_mov_b32 v2, 2147483632
  v_cmp_gt_u32 vcc, 3, v0
  s_cmp_eq_u32 s100, 1
  s_nop 2
  s_cselect_b64 vcc, vcc, 0
  v_cndmask_b32 v98, v2, v98, vcc
  s_mov_b32 s101, 6
  s_call_b64 s[30:31], L_t1bsub
  s_waitcnt vmcnt(0)
  s_lshl_b32 s8, s5, 3
  s_add_u32 s8, s8, s4
  s_lshl_b32 s8, s8, 7
  s_lshl_b32 s9, s51, 2
  s_add_u32 s8, s8, s9
  s_add_u32 s8, s8, 65536
  v_mov_b32 v2, s7
  v_mov_b32 v3, 0
  s_mov_b64 exec, 1
  buffer_store_dword v2, v3, s[52:55], s8 offen sc1
  s_mov_b64 exec, -1
  s_mov_b32 s101, 4
  s_call_b64 s[30:31], L_t1bsub
  v_mfma_f32_16x16x32_bf16 v[16:19], v[132:135], v[140:143], v[16:19]
  v_mfma_f32_16x16x32_bf16 v[20:23], v[136:139], v[140:143], v[20:23]
  v_mfma_f32_16x16x32_bf16 v[24:27], v[132:135], v[144:147], v[24:27]
  v_mfma_f32_16x16x32_bf16 v[28:31], v[136:139], v[144:147], v[28:31]
  v_mfma_f32_16x16x32_bf16 v[32:35], v[132:135], v[148:151], v[32:35]
  v_mfma_f32_16x16x32_bf16 v[36:39], v[136:139], v[148:151], v[36:39]
  v_mfma_f32_16x16x32_bf16 v[40:43], v[132:135], v[152:155], v[40:43]
  v_mfma_f32_16x16x32_bf16 v[44:47], v[136:139], v[152:155], v[44:47]
  v_mfma_f32_16x16x32_bf16 v[48:51], v[132:135], v[156:159], v[48:51]
  v_mfma_f32_16x16x32_bf16 v[52:55], v[136:139], v[156:159], v[52:55]
  s_barrier
  s_and_b32 s9, s51, 1
  s_mul_i32 s9, s9, 80
  v_add_u32 v2, s9, v234
  v_lshlrev_b32 v2, 5, v2
  v_add_u32 v2, 143360, v2
  ds_read_b128 v[194:197], v2 offset:0
  ds_read_b128 v[198:201], v2 offset:16
  ds_read_b128 v[202:205], v2 offset:512
  ds_read_b128 v[206:209], v2 offset:528
  ds_read_b128 v[210:213], v2 offset:1024
  ds_read_b128 v[214:217], v2 offset:1040
  ds_read_b128 v[218:221], v2 offset:1536
  ds_read_b128 v[222:225], v2 offset:1552
  ds_read_b128 v[226:229], v2 offset:2048
  ds_read_b128 v[230:233], v2 offset:2064
  s_lshr_b32 s8, s51, 1
  s_lshl_b32 s8, s8, 7
  v_lshl_add_u32 v2, v235, 5, s8
  v_add_u32 v2, 155648, v2
  ds_read_b128 v[100:103], v2 offset:256
  ds_read_b128 v[104:107], v2 offset:272
  s_and_b32 s8, s51, 1
  s_mul_i32 s8, s8, 80
  v_add_u32 v2, s8, v234
  v_lshlrev_b32 v5, 5, v2
  v_add_u32 v5, 155648, v5
  s_lshr_b32 s9, s51, 1
  s_lshl_b32 s9, s9, 2
  v_add_u32 v4, s9, v235
  v_lshl_add_u32 v4, v4, 2, v5
  s_waitcnt lgkmcnt(0)
  v_mul_f32 v16, v16, v100
  v_mul_f32 v24, v24, v100
  v_mul_f32 v32, v32, v100
  v_mul_f32 v40, v40, v100
  v_mul_f32 v48, v48, v100
  v_mul_f32 v17, v17, v101
  v_mul_f32 v25, v25, v101
  v_mul_f32 v33, v33, v101
  v_mul_f32 v41, v41, v101
  v_mul_f32 v49, v49, v101
  v_fmac_f32 v17, v194, v16
  v_fmac_f32 v25, v202, v24
  v_fmac_f32 v33, v210, v32
  v_fmac_f32 v41, v218, v40
  v_fmac_f32 v49, v226, v48
  v_fmac_f32_dpp v17, v16, v195 row_ror:8 row_mask:0xf bank_mask:0xf
  v_fmac_f32_dpp v25, v24, v203 row_ror:8 row_mask:0xf bank_mask:0xf
  v_fmac_f32_dpp v33, v32, v211 row_ror:8 row_mask:0xf bank_mask:0xf
  v_fmac_f32_dpp v41, v40, v219 row_ror:8 row_mask:0xf bank_mask:0xf
  v_fmac_f32_dpp v49, v48, v227 row_ror:8 row_mask:0xf bank_mask:0xf
  v_mul_f32 v18, v18, v102
  v_mul_f32 v26, v26, v102
  v_mul_f32 v34, v34, v102
  v_mul_f32 v42, v42, v102
  v_mul_f32 v50, v50, v102
  v_fmac_f32 v18, v194, v17
  v_fmac_f32 v26, v202, v25
  v_fmac_f32 v34, v210, v33
  v_fmac_f32 v42, v218, v41
  v_fmac_f32 v50, v226, v49
  v_fmac_f32_dpp v18, v17, v195 row_ror:8 row_mask:0xf bank_mask:0xf
  v_fmac_f32_dpp v26, v25, v203 row_ror:8 row_mask:0xf bank_mask:0xf
  v_fmac_f32_dpp v34, v33, v211 row_ror:8 row_mask:0xf bank_mask:0xf
  v_fmac_f32_dpp v42, v41, v219 row_ror:8 row_mask:0xf bank_mask:0xf
  v_fmac_f32_dpp v50, v49, v227 row_ror:8 row_mask:0xf bank_mask:0xf
  v_mul_f32 v19, v19, v103
  v_mul_f32 v27, v27, v103
  v_mul_f32 v35, v35, v103
  v_mul_f32 v43, v43, v103
  v_mul_f32 v51, v51, v103
  v_fmac_f32 v19, v194, v18
  v_fmac_f32 v27, v202, v26
  v_fmac_f32 v35, v210, v34
  v_fmac_f32 v43, v218, v42
  v_fmac_f32 v51, v226, v50
  v_fmac_f32_dpp v19, v18, v195 row_ror:8 row_mask:0xf bank_mask:0xf
  v_fmac_f32_dpp v27, v26, v203 row_ror:8 row_mask:0xf bank_mask:0xf
  v_fmac_f32_dpp v35, v34, v211 row_ror:8 row_mask:0xf bank_mask:0xf
  v_fmac_f32_dpp v43, v42, v219 row_ror:8 row_mask:0xf bank_mask:0xf
  v_fmac_f32_dpp v51, v50, v227 row_ror:8 row_mask:0xf bank_mask:0xf
  v_mul_f32 v20, v20, v104
  v_mul_f32 v28, v28, v104
  v_mul_f32 v36, v36, v104
  v_mul_f32 v44, v44, v104
  v_mul_f32 v52, v52, v104
  v_fmac_f32 v20, v194, v19
  v_fmac_f32 v28, v202, v27
  v_fmac_f32 v36, v210, v35
  v_fmac_f32 v44, v218, v43
  v_fmac_f32 v52, v226, v51
  v_fmac_f32_dpp v20, v19, v195 row_ror:8 row_mask:0xf bank_mask:0xf
  v_fmac_f32_dpp v28, v27, v203 row_ror:8 row_mask:0xf bank_mask:0xf
  v_fmac_f32_dpp v36, v35, v211 row_ror:8 row_mask:0xf bank_mask:0xf
  v_fmac_f32_dpp v44, v43, v219 row_ror:8 row_mask:0xf bank_mask:0xf
  v_fmac_f32_dpp v52, v51, v227 row_ror:8 row_mask:0xf bank_mask:0xf
  v_mul_f32 v21, v21, v105
  v_mul_f32 v29, v29, v105
  v_mul_f32 v37, v37, v105
  v_mul_f32 v45, v45, v105
  v_mul_f32 v53, v53, v105
  v_fmac_f32 v21, v194, v20
  v_fmac_f32 v29, v202, v28
  v_fmac_f32 v37, v210, v36
  v_fmac_f32 v45, v218, v44
  v_fmac_f32 v53, v226, v52
  v_fmac_f32_dpp v21, v20, v195 row_ror:8 row_mask:0xf bank_mask:0xf
  v_fmac_f32_dpp v29, v28, v203 row_ror:8 row_mask:0xf bank_mask:0xf
  v_fmac_f32_dpp v37, v36, v211 row_ror:8 row_mask:0xf bank_mask:0xf
  v_fmac_f32_dpp v45, v44, v219 row_ror:8 row_mask:0xf bank_mask:0xf
  v_fmac_f32_dpp v53, v52, v227 row_ror:8 row_mask:0xf bank_mask:0xf
  v_mul_f32 v22, v22, v106
  v_mul_f32 v30, v30, v106
  v_mul_f32 v38, v38, v106
  v_mul_f32 v46, v46, v106
  v_mul_f32 v54, v54, v106
  v_fmac_f32 v22, v194, v21
  v_fmac_f32 v30, v202, v29
  v_fmac_f32 v38, v210, v37
  v_fmac_f32 v46, v218, v45
  v_fmac_f32 v54, v226, v53
  v_fmac_f32_dpp v22, v21, v195 row_ror:8 row_mask:0xf bank_mask:0xf
  v_fmac_f32_dpp v30, v29, v203 row_ror:8 row_mask:0xf bank_mask:0xf
  v_fmac_f32_dpp v38, v37, v211 row_ror:8 row_mask:0xf bank_mask:0xf
  v_fmac_f32_dpp v46, v45, v219 row_ror:8 row_mask:0xf bank_mask:0xf
  v_fmac_f32_dpp v54, v53, v227 row_ror:8 row_mask:0xf bank_mask:0xf
  v_mul_f32 v23, v23, v107
  v_mul_f32 v31, v31, v107
  v_mul_f32 v39, v39, v107
  v_mul_f32 v47, v47, v107
  v_mul_f32 v55, v55, v107
  v_fmac_f32 v23, v194, v22
  v_fmac_f32 v31, v202, v30
  v_fmac_f32 v39, v210, v38
  v_fmac_f32 v47, v218, v46
  v_fmac_f32 v55, v226, v54
  v_fmac_f32_dpp v23, v22, v195 row_ror:8 row_mask:0xf bank_mask:0xf
  v_fmac_f32_dpp v31, v30, v203 row_ror:8 row_mask:0xf bank_mask:0xf
  v_fmac_f32_dpp v39, v38, v211 row_ror:8 row_mask:0xf bank_mask:0xf
  v_fmac_f32_dpp v47, v46, v219 row_ror:8 row_mask:0xf bank_mask:0xf
  v_fmac_f32_dpp v55, v54, v227 row_ror:8 row_mask:0xf bank_mask:0xf
  ds_write_b32 v4, v23 offset:2560
  ds_write_b32 v4, v31 offset:3072
  ds_write_b32 v4, v39 offset:3584
  ds_write_b32 v4, v47 offset:4096
  ds_write_b32 v4, v55 offset:4608
  v_mov_b32 v2, 157056
  s_waitcnt lgkmcnt(0)
  v_mov_b32 v3, 1
  s_mov_b64 exec, 1
  ds_add_u32 v2, v3
  s_mov_b64 exec, -1
  s_mov_b32 s12, 0
L_spin0:
  ds_read_b32 v3, v2
  s_add_u32 s12, s12, 1
  s_waitcnt lgkmcnt(0)
  v_readfirstlane_b32 s11, v3
  s_nop 3
  s_cmp_ge_u32 s11, 4
  s_cbranch_scc1 L_spind0
  s_cmp_lt_u32 s12, 0x100000
  s_cbranch_scc1 L_spin0
L_spind0:
  ds_read_b128 v[100:103], v5 offset:2560
  ds_read_b128 v[104:107], v5 offset:2576
  ds_read_b128 v[108:111], v5 offset:3072
  ds_read_b128 v[112:115], v5 offset:3088
  ds_read_b128 v[116:119], v5 offset:3584
  ds_read_b128 v[120:123], v5 offset:3600
  ds_read_b128 v[124:127], v5 offset:4096
  ds_read_b128 v[128:131], v5 offset:4112
  ds_read_b128 v[132:135], v5 offset:4608
  ds_read_b128 v[136:139], v5 offset:4624
  s_waitcnt lgkmcnt(0)
  v_fmac_f32 v101, v196, v100
  v_fmac_f32 v109, v204, v108
  v_fmac_f32 v117, v212, v116
  v_fmac_f32 v125, v220, v124
  v_fmac_f32 v133, v228, v132
  v_fmac_f32_dpp v101, v100, v197 row_ror:8 row_mask:0xf bank_mask:0xf
  v_fmac_f32_dpp v109, v108, v205 row_ror:8 row_mask:0xf bank_mask:0xf
  v_fmac_f32_dpp v117, v116, v213 row_ror:8 row_mask:0xf bank_mask:0xf
  v_fmac_f32_dpp v125, v124, v221 row_ror:8 row_mask:0xf bank_mask:0xf
  v_fmac_f32_dpp v133, v132, v229 row_ror:8 row_mask:0xf bank_mask:0xf
  v_fmac_f32 v102, v196, v101
  v_fmac_f32 v110, v204, v109
  v_fmac_f32 v118, v212, v117
  v_fmac_f32 v126, v220, v125
  v_fmac_f32 v134, v228, v133
  v_fmac_f32_dpp v102, v101, v197 row_ror:8 row_mask:0xf bank_mask:0xf
  v_fmac_f32_dpp v110, v109, v205 row_ror:8 row_mask:0xf bank_mask:0xf
  v_fmac_f32_dpp v118, v117, v213 row_ror:8 row_mask:0xf bank_mask:0xf
  v_fmac_f32_dpp v126, v125, v221 row_ror:8 row_mask:0xf bank_mask:0xf
  v_fmac_f32_dpp v134, v133, v229 row_ror:8 row_mask:0xf bank_mask:0xf
  v_fmac_f32 v103, v196, v102
  v_fmac_f32 v111, v204, v110
  v_fmac_f32 v119, v212, v118
  v_fmac_f32 v127, v220, v126
  v_fmac_f32 v135, v228, v134
  v_fmac_f32_dpp v103, v102, v197 row_ror:8 row_mask:0xf bank_mask:0xf
  v_fmac_f32_dpp v111, v110, v205 row_ror:8 row_mask:0xf bank_mask:0xf
  v_fmac_f32_dpp v119, v118, v213 row_ror:8 row_mask:0xf bank_mask:0xf
  v_fmac_f32_dpp v127, v126, v221 row_ror:8 row_mask:0xf bank_mask:0xf
  v_fmac_f32_dpp v135, v134, v229 row_ror:8 row_mask:0xf bank_mask:0xf
  v_fmac_f32 v104, v196, v103
  v_fmac_f32 v112, v204, v111
  v_fmac_f32 v120, v212, v119
  v_fmac_f32 v128, v220, v127
  v_fmac_f32 v136, v228, v135
  v_fmac_f32_dpp v104, v103, v197 row_ror:8 row_mask:0xf bank_mask:0xf
  v_fmac_f32_dpp v112, v111, v205 row_ror:8 row_mask:0xf bank_mask:0xf
  v_fmac_f32_dpp v120, v119, v213 row_ror:8 row_mask:0xf bank_mask:0xf
  v_fmac_f32_dpp v128, v127, v221 row_ror:8 row_mask:0xf bank_mask:0xf
  v_fmac_f32_dpp v136, v135, v229 row_ror:8 row_mask:0xf bank_mask:0xf
  v_fmac_f32 v105, v196, v104
  v_fmac_f32 v113, v204, v112
  v_fmac_f32 v121, v212, v120
  v_fmac_f32 v129, v220, v128
  v_fmac_f32 v137, v228, v136
  v_fmac_f32_dpp v105, v104, v197 row_ror:8 row_mask:0xf bank_mask:0xf
  v_fmac_f32_dpp v113, v112, v205 row_ror:8 row_mask:0xf bank_mask:0xf
  v_fmac_f32_dpp v121, v120, v213 row_ror:8 row_mask:0xf bank_mask:0xf
  v_fmac_f32_dpp v129, v128, v221 row_ror:8 row_mask:0xf bank_mask:0xf
  v_fmac_f32_dpp v137, v136, v229 row_ror:8 row_mask:0xf bank_mask:0xf
  v_fmac_f32 v106, v196, v105
  v_fmac_f32 v114, v204, v113
  v_fmac_f32 v122, v212, v121
  v_fmac_f32 v130, v220, v129
  v_fmac_f32 v138, v228, v137
  v_fmac_f32_dpp v106, v105, v197 row_ror:8 row_mask:0xf bank_mask:0xf
  v_fmac_f32_dpp v114, v113, v205 row_ror:8 row_mask:0xf bank_mask:0xf
  v_fmac_f32_dpp v122, v121, v213 row_ror:8 row_mask:0xf bank_mask:0xf
  v_fmac_f32_dpp v130, v129, v221 row_ror:8 row_mask:0xf bank_mask:0xf
  v_fmac_f32_dpp v138, v137, v229 row_ror:8 row_mask:0xf bank_mask:0xf
  v_fmac_f32 v107, v196, v106
  v_fmac_f32 v115, v204, v114
  v_fmac_f32 v123, v212, v122
  v_fmac_f32 v131, v220, v130
  v_fmac_f32 v139, v228, v138
  v_fmac_f32_dpp v107, v106, v197 row_ror:8 row_mask:0xf bank_mask:0xf
  v_fmac_f32_dpp v115, v114, v205 row_ror:8 row_mask:0xf bank_mask:0xf
  v_fmac_f32_dpp v123, v122, v213 row_ror:8 row_mask:0xf bank_mask:0xf
  v_fmac_f32_dpp v131, v130, v221 row_ror:8 row_mask:0xf bank_mask:0xf
  v_fmac_f32_dpp v139, v138, v229 row_ror:8 row_mask:0xf bank_mask:0xf
  v_cmp_eq_u32 s[96:97], 1, v235
  v_cmp_eq_u32 s[98:99], 2, v235
  v_cmp_eq_u32 vcc, 3, v235
  s_cmp_ge_u32 s51, 2
  s_cbranch_scc1 L_sel1
  v_cndmask_b32 v196, 0, v100, s[96:97]
  v_cndmask_b32 v196, v196, v101, s[98:99]
  v_cndmask_b32 v196, v196, v102, vcc
  v_cndmask_b32 v204, 0, v108, s[96:97]
  v_cndmask_b32 v204, v204, v109, s[98:99]
  v_cndmask_b32 v204, v204, v110, vcc
  v_cndmask_b32 v212, 0, v116, s[96:97]
  v_cndmask_b32 v212, v212, v117, s[98:99]
  v_cndmask_b32 v212, v212, v118, vcc
  v_cndmask_b32 v220, 0, v124, s[96:97]
  v_cndmask_b32 v220, v220, v125, s[98:99]
  v_cndmask_b32 v220, v220, v126, vcc
  v_cndmask_b32 v228, 0, v132, s[96:97]
  v_cndmask_b32 v228, v228, v133, s[98:99]
  v_cndmask_b32 v228, v228, v134, vcc
  s_branch L_sel_done
L_sel1:
  v_cndmask_b32 v196, v103, v104, s[96:97]
  v_cndmask_b32 v196, v196, v105, s[98:99]
  v_cndmask_b32 v196, v196, v106, vcc
  v_cndmask_b32 v204, v111, v112, s[96:97]
  v_cndmask_b32 v204, v204, v113, s[98:99]
  v_cndmask_b32 v204, v204, v114, vcc
  v_cndmask_b32 v212, v119, v120, s[96:97]
  v_cndmask_b32 v212, v212, v121, s[98:99]
  v_cndmask_b32 v212, v212, v122, vcc
  v_cndmask_b32 v220, v127, v128, s[96:97]
  v_cndmask_b32 v220, v220, v129, s[98:99]
  v_cndmask_b32 v220, v220, v130, vcc
  v_cndmask_b32 v228, v135, v136, s[96:97]
  v_cndmask_b32 v228, v228, v137, s[98:99]
  v_cndmask_b32 v228, v228, v138, vcc
  s_and_b32 s8, s51, 1
  s_mul_i32 s8, s8, 40
  v_and_b32 v2, 7, v234
  v_add_u32 v2, s8, v2
  v_lshrrev_b32 v3, 3, v234
  v_lshlrev_b32 v3, 3, v3
  v_lshl_add_u32 v2, v2, 4, v3
  s_lshl_b32 s10, s5, 3
  s_add_u32 s10, s10, s4
  s_mul_i32 s10, s10, 1280
  s_add_u32 s10, s10, 262144
  v_mov_b32 v7, s7
  v_mov_b32 v9, s7
  s_mov_b64 exec, 0xffff
  v_mov_b32 v6, v107
  buffer_store_dwordx2 v[6:7], v2, s[52:55], s10 offen offset:0 sc1
  v_mov_b32 v8, v115
  buffer_store_dwordx2 v[8:9], v2, s[52:55], s10 offen offset:128 sc1
  v_mov_b32 v6, v123
  buffer_store_dwordx2 v[6:7], v2, s[52:55], s10 offen offset:256 sc1
  v_mov_b32 v8, v131
  buffer_store_dwordx2 v[8:9], v2, s[52:55], s10 offen offset:384 sc1
  v_mov_b32 v6, v139
  buffer_store_dwordx2 v[6:7], v2, s[52:55], s10 offen offset:512 sc1
  s_mov_b64 exec, -1
L_sel_done:
  v_mov_b32 v76, 0
  v_mov_b32 v77, 0
  v_mov_b32 v78, 0
  v_mov_b32 v79, 0
  v_mov_b32 v80, 0
  v_mov_b32 v81, 0
  v_mov_b32 v82, 0
  v_mov_b32 v83, 0
  v_mov_b32 v84, 0
  v_mov_b32 v85, 0
  v_mov_b32 v86, 0
  v_mov_b32 v87, 0
  v_mov_b32 v88, 0
  v_mov_b32 v89, 0
  v_mov_b32 v90, 0
  v_mov_b32 v91, 0
  v_mov_b32 v92, 0
  v_mov_b32 v93, 0
  v_mov_b32 v94, 0
  v_mov_b32 v95, 0
  v_mov_b32 v132, 0
  v_mov_b32 v133, 0
  v_mov_b32 v134, 0
  v_mov_b32 v135, 0
  v_mov_b32 v136, 0
  v_mov_b32 v137, 0
  v_mov_b32 v138, 0
  v_mov_b32 v139, 0
  v_mov_b32 v140, 0
  v_mov_b32 v141, 0
  v_mov_b32 v142, 0
  v_mov_b32 v143, 0
  v_mov_b32 v144, 0
  v_mov_b32 v145, 0
  v_mov_b32 v146, 0
  v_mov_b32 v147, 0
  v_mov_b32 v148, 0
  v_mov_b32 v149, 0
  v_mov_b32 v150, 0
  v_mov_b32 v151, 0
  v_mov_b32 v152, 0
  v_mov_b32 v153, 0
  v_mov_b32 v154, 0
  v_mov_b32 v155, 0
  s_mov_b32 s65, 0
  s_mul_i32 s8, s64, 20480
  v_add_u32 v254, s8, v236
  v_add_u32 v255, s65, v237
  v_add_u32 v15, s65, v238
  s_mov_b32 s101, 5
  s_call_b64 s[30:31], L_gemm80
  v_mfma_f32_16x16x32_bf16 v[76:79], v[136:139], v[132:135], v[76:79]
  v_mfma_f32_16x16x32_bf16 v[80:83], v[140:143], v[132:135], v[80:83]
  v_mfma_f32_16x16x32_bf16 v[84:87], v[144:147], v[132:135], v[84:87]
  v_mfma_f32_16x16x32_bf16 v[88:91], v[148:151], v[132:135], v[88:91]
  v_mfma_f32_16x16x32_bf16 v[92:95], v[152:155], v[132:135], v[92:95]
  s_barrier
  v_mul_f32 v100, v245, v246
  v_sub_f32 v100, 0, v100
  v_mov_b32 v101, v100
  v_mov_b32 v102, v246
  v_mov_b32 v103, v246
  v_lshlrev_b32 v104, 16, v164
  v_and_b32 v105, s66, v164
  v_pk_add_f32 v[76:77], v[76:77], v[100:101]
  v_pk_fma_f32 v[76:77], v[104:105], v[102:103], v[76:77]
  v_cvt_pk_bf16_f32 v174, v76, v77
  v_lshlrev_b32 v106, 16, v165
  v_and_b32 v107, s66, v165
  v_pk_add_f32 v[78:79], v[78:79], v[100:101]
  v_pk_fma_f32 v[78:79], v[106:107], v[102:103], v[78:79]
  v_cvt_pk_bf16_f32 v175, v78, v79
  v_lshlrev_b32 v104, 16, v166
  v_and_b32 v105, s66, v166
  v_pk_add_f32 v[80:81], v[80:81], v[100:101]
  v_pk_fma_f32 v[80:81], v[104:105], v[102:103], v[80:81]
  v_cvt_pk_bf16_f32 v176, v80, v81
  v_lshlrev_b32 v106, 16, v167
  v_and_b32 v107, s66, v167
  v_pk_add_f32 v[82:83], v[82:83], v[100:101]
  v_pk_fma_f32 v[82:83], v[106:107], v[102:103], v[82:83]
  v_cvt_pk_bf16_f32 v177, v82, v83
  v_lshlrev_b32 v104, 16, v168
  v_and_b32 v105, s66, v168
  v_pk_add_f32 v[84:85], v[84:85], v[100:101]
  v_pk_fma_f32 v[84:85], v[104:105], v[102:103], v[84:85]
  v_cvt_pk_bf16_f32 v178, v84, v85
  v_lshlrev_b32 v106, 16, v169
  v_and_b32 v107, s66, v169
  v_pk_add_f32 v[86:87], v[86:87], v[100:101]
  v_pk_fma_f32 v[86:87], v[106:107], v[102:103], v[86:87]
  v_cvt_pk_bf16_f32 v179, v86, v87
  v_lshlrev_b32 v104, 16, v170
  v_and_b32 v105, s66, v170
  v_pk_add_f32 v[88:89], v[88:89], v[100:101]
  v_pk_fma_f32 v[88:89], v[104:105], v[102:103], v[88:89]
  v_cvt_pk_bf16_f32 v180, v88, v89
  v_lshlrev_b32 v106, 16, v171
  v_and_b32 v107, s66, v171
  v_pk_add_f32 v[90:91], v[90:91], v[100:101]
  v_pk_fma_f32 v[90:91], v[106:107], v[102:103], v[90:91]
  v_cvt_pk_bf16_f32 v181, v90, v91
  v_lshlrev_b32 v104, 16, v172
  v_and_b32 v105, s66, v172
  v_pk_add_f32 v[92:93], v[92:93], v[100:101]
  v_pk_fma_f32 v[92:93], v[104:105], v[102:103], v[92:93]
  v_cvt_pk_bf16_f32 v182, v92, v93
  v_lshlrev_b32 v106, 16, v173
  v_and_b32 v107, s66, v173
  v_pk_add_f32 v[94:95], v[94:95], v[100:101]
  v_pk_fma_f32 v[94:95], v[106:107], v[102:103], v[94:95]
  v_cvt_pk_bf16_f32 v183, v94, v95
  s_mul_i32 s9, s51, 2560
  v_mul_u32_u24 v2, 160, v234
  v_lshl_add_u32 v2, v235, 3, v2
  v_add_u32 v2, s9, v2
  v_lshlrev_b32 v9, 4, v0
  v_add_u32 v9, s9, v9
  ds_write_b64 v2, v[174:175] offset:0
  ds_write_b64 v2, v[176:177] offset:32
  ds_write_b64 v2, v[178:179] offset:64
  ds_write_b64 v2, v[180:181] offset:96
  ds_write_b64 v2, v[182:183] offset:128
  s_waitcnt lgkmcnt(0)
  ds_read_b128 v[140:143], v9 offset:0
  ds_read_b128 v[144:147], v9 offset:1024
  ds_read_b128 v[148:151], v9 offset:2048
  s_mov_b32 s9, 4194304
  s_waitcnt lgkmcnt(0)
  buffer_store_dwordx4 v[140:143], v192, s[52:55], s9 offen
  buffer_store_dwordx4 v[144:147], v193, s[52:55], s9 offen
  buffer_store_dwordx4 v[148:151], v99, s[52:55], s9 offen
  v_mov_b32 v108, 0
  v_mov_b32 v110, 0
  v_dot2c_f32_bf16 v108, s14, v174
  v_dot2c_f32_bf16 v110, v174, v174
  v_dot2c_f32_bf16 v108, s14, v175
  v_dot2c_f32_bf16 v110, v175, v175
  v_dot2c_f32_bf16 v108, s14, v176
  v_dot2c_f32_bf16 v110, v176, v176
  v_dot2c_f32_bf16 v108, s14, v177
  v_dot2c_f32_bf16 v110, v177, v177
  v_dot2c_f32_bf16 v108, s14, v178
  v_dot2c_f32_bf16 v110, v178, v178
  v_dot2c_f32_bf16 v108, s14, v179
  v_dot2c_f32_bf16 v110, v179, v179
  v_dot2c_f32_bf16 v108, s14, v180
  v_dot2c_f32_bf16 v110, v180, v180
  v_dot2c_f32_bf16 v108, s14, v181
  v_dot2c_f32_bf16 v110, v181, v181
  v_dot2c_f32_bf16 v108, s14, v182
  v_dot2c_f32_bf16 v110, v182, v182
  v_dot2c_f32_bf16 v108, s14, v183
  v_dot2c_f32_bf16 v110, v183, v183
  s_nop 1
  v_mov_b32 v112, v108
  s_nop 1
  v_permlane16_swap_b32 v108, v112
  v_add_f32 v108, v108, v112
  v_mov_b32 v112, v108
  s_nop 1
  v_permlane32_swap_b32 v108, v112
  v_add_f32 v108, v108, v112
  v_mov_b32 v113, v110
  s_nop 1
  v_permlane16_swap_b32 v110, v113
  v_add_f32 v110, v110, v113
  v_mov_b32 v113, v110
  s_nop 1
  v_permlane32_swap_b32 v110, v113
  v_add_f32 v110, v110, v113
  v_mov_b32 v109, s7
  v_mov_b32 v111, s7
  s_lshl_b32 s8, s51, 4
  v_add_u32 v2, s8, v234
  v_lshlrev_b32 v2, 7, v2
  s_lshl_b32 s9, s5, 13
  s_lshl_b32 s10, s4, 4
  s_add_u32 s9, s9, s10
  s_add_u32 s9, s9, 655360
  s_mov_b64 exec, 0xffff
  buffer_store_dwordx4 v[108:111], v2, s[52:55], s9 offen
  s_mov_b64 exec, -1
  s_waitcnt vmcnt(1)
  s_cmp_eq_u32 s100, 1
  s_cbranch_scc1 L_pubf2
  s_waitcnt vmcnt(0)
  buffer_wbl2 sc1
  s_waitcnt vmcnt(0)
L_pubf2:
  s_lshl_b32 s8, s5, 3
  s_add_u32 s8, s8, s4
  s_lshl_b32 s8, s8, 7
  s_lshl_b32 s9, s51, 2
  s_add_u32 s8, s8, s9
  s_add_u32 s8, s8, 98304
  v_mov_b32 v2, s7
  v_mov_b32 v3, 0
  s_mov_b64 exec, 1
  s_cmp_eq_u32 s100, 1
  s_cbranch_scc1 L_pubg2
  buffer_store_dword v2, v3, s[52:55], s8 offen sc1
  s_branch L_pubh2
L_pubg2:
  buffer_store_dword v2, v3, s[52:55], s8 offen
L_pubh2:
  s_mov_b64 exec, -1
  v_cmp_gt_u32 vcc, 8, v234
  v_mov_b32 v9, 1.0
  v_mov_b32 v8, -1.0
  v_cndmask_b32 v9, v9, v8, vcc
  s_lshr_b32 s9, s51, 1
  s_lshl_b32 s9, s9, 2
  v_add_u32 v5, s9, v235
  v_lshlrev_b32 v5, 3, v5
  v_cvt_f32_u32 v5, v5
  v_mul_f32 v3, v5, v198
  v_mul_f32 v4, v5, v199
  v_mul_f32 v3, 0x3fb8aa3b, v3
  v_mul_f32 v4, 0x3e22f983, v4
  v_exp_f32 v3, v3
  v_fract_f32 v4, v4
  v_cos_f32 v156, v4
  v_sin_f32 v161, v4
  v_mul_f32 v156, v156, v3
  v_mul_f32 v161, v161, v3
  v_mul_f32 v161, v161, v9
  v_mul_f32 v3, v5, v206
  v_mul_f32 v4, v5, v207
  v_mul_f32 v3, 0x3fb8aa3b, v3
  v_mul_f32 v4, 0x3e22f983, v4
  v_exp_f32 v3, v3
  v_fract_f32 v4, v4
  v_cos_f32 v157, v4
  v_sin_f32 v162, v4
  v_mul_f32 v157, v157, v3
  v_mul_f32 v162, v162, v3
  v_mul_f32 v162, v162, v9
  v_mul_f32 v3, v5, v214
  v_mul_f32 v4, v5, v215
  v_mul_f32 v3, 0x3fb8aa3b, v3
  v_mul_f32 v4, 0x3e22f983, v4
  v_exp_f32 v3, v3
  v_fract_f32 v4, v4
  v_cos_f32 v158, v4
  v_sin_f32 v163, v4
  v_mul_f32 v158, v158, v3
  v_mul_f32 v163, v163, v3
  v_mul_f32 v163, v163, v9
  v_mul_f32 v3, v5, v222
  v_mul_f32 v4, v5, v223
  v_mul_f32 v3, 0x3fb8aa3b, v3
  v_mul_f32 v4, 0x3e22f983, v4
  v_exp_f32 v3, v3
  v_fract_f32 v4, v4
  v_cos_f32 v159, v4
  v_sin_f32 v96, v4
  v_mul_f32 v159, v159, v3
  v_mul_f32 v96, v96, v3
  v_mul_f32 v96, v96, v9
  v_mul_f32 v3, v5, v230
  v_mul_f32 v4, v5, v231
  v_mul_f32 v3, 0x3fb8aa3b, v3
  v_mul_f32 v4, 0x3e22f983, v4
  v_exp_f32 v3, v3
  v_fract_f32 v4, v4
  v_cos_f32 v160, v4
  v_sin_f32 v97, v4
  v_mul_f32 v160, v160, v3
  v_mul_f32 v97, v97, v3
  v_mul_f32 v97, v97, v9
  s_lshr_b32 s8, s51, 1
  s_lshl_b32 s8, s8, 5
  v_add_u32 v2, s8, v234
  v_and_b32 v3, 2, v234
  v_lshrrev_b32 v4, 1, v234
  v_and_b32 v4, 4, v4
  v_or_b32 v3, v3, v4
  v_xor_b32 v3, v3, v235
  v_lshlrev_b32 v3, 4, v3
  v_lshl_add_u32 v239, v2, 7, v3
  v_xor_b32 v240, 64, v239
  v_lshrrev_b32 v2, 1, v235
  v_lshlrev_b32 v2, 4, v2
  v_and_b32 v3, 1, v235
  v_lshl_add_u32 v2, v3, 2, v2
  v_lshrrev_b32 v3, 2, v234
  v_add_u32 v2, v2, v3
  v_mul_u32_u24 v4, 384, v2
  v_and_b32 v5, 1, v0
  v_lshl_add_u32 v4, v5, 3, v4
  v_add_u32 v4, 81920, v4
  v_and_b32 v5, 6, v2
  v_bfe_u32 v10, v0, 1, 1
  s_and_b32 s9, s51, 1
  s_mul_i32 s9, s9, 12
  s_mul_i32 s11, s64, 24576
  v_add_u32 v4, s11, v4
  s_lshr_b32 s8, s51, 1
  s_mul_i32 s8, s8, 6
  s_add_u32 s10, s8, 0
  s_cmp_ge_u32 s10, 12
  s_cselect_b32 s11, 12, 0
  s_sub_u32 s10, s10, s11
  s_add_u32 s10, s10, s9
  v_xor_b32 v11, s10, v5
  v_add_u32 v11, v11, v10
  v_lshl_add_u32 v248, v11, 4, v4
  s_add_u32 s10, s8, 2
  s_cmp_ge_u32 s10, 12
  s_cselect_b32 s11, 12, 0
  s_sub_u32 s10, s10, s11
  s_add_u32 s10, s10, s9
  v_xor_b32 v11, s10, v5
  v_add_u32 v11, v11, v10
  v_lshl_add_u32 v249, v11, 4, v4
  s_add_u32 s10, s8, 4
  s_cmp_ge_u32 s10, 12
  s_cselect_b32 s11, 12, 0
  s_sub_u32 s10, s10, s11
  s_add_u32 s10, s10, s9
  v_xor_b32 v11, s10, v5
  v_add_u32 v11, v11, v10
  v_lshl_add_u32 v250, v11, 4, v4
  s_add_u32 s10, s8, 6
  s_cmp_ge_u32 s10, 12
  s_cselect_b32 s11, 12, 0
  s_sub_u32 s10, s10, s11
  s_add_u32 s10, s10, s9
  v_xor_b32 v11, s10, v5
  v_add_u32 v11, v11, v10
  v_lshl_add_u32 v251, v11, 4, v4
  s_add_u32 s10, s8, 8
  s_cmp_ge_u32 s10, 12
  s_cselect_b32 s11, 12, 0
  s_sub_u32 s10, s10, s11
  s_add_u32 s10, s10, s9
  v_xor_b32 v11, s10, v5
  v_add_u32 v11, v11, v10
  v_lshl_add_u32 v252, v11, 4, v4
  s_add_u32 s10, s8, 10
  s_cmp_ge_u32 s10, 12
  s_cselect_b32 s11, 12, 0
  s_sub_u32 s10, s10, s11
  s_add_u32 s10, s10, s9
  v_xor_b32 v11, s10, v5
  v_add_u32 v11, v11, v10
  v_lshl_add_u32 v253, v11, 4, v4
  s_lshr_b32 s8, s51, 1
  s_lshl_b32 s8, s8, 5
  v_add_u32 v2, s8, v234
  v_lshlrev_b32 v2, 7, v2
  v_lshl_add_u32 v87, v235, 5, v2
  s_lshl_b32 s9, s5, 13
  s_add_u32 s9, s9, 655360
  buffer_load_dwordx4 v[100:103], v87, s[52:55], s9 offen offset:0 sc1
  buffer_load_dwordx4 v[104:107], v87, s[52:55], s9 offen offset:16 sc1
  buffer_load_dwordx4 v[108:111], v87, s[52:55], s9 offen offset:2048 sc1
  buffer_load_dwordx4 v[112:115], v87, s[52:55], s9 offen offset:2064 sc1
  v_mov_b32 v2, 157064
  s_mov_b32 s12, 0
L_spin1:
  ds_read_b32 v3, v2
  s_add_u32 s12, s12, 1
  s_waitcnt lgkmcnt(0)
  v_readfirstlane_b32 s11, v3
  s_nop 3
  s_cmp_ge_u32 s11, 4
  s_cbranch_scc1 L_spind1
  s_cmp_lt_u32 s12, 0x100000
  s_cbranch_scc1 L_spin1
L_spind1:
  s_and_b32 s8, s51, 1
  s_mul_i32 s8, s8, 80
  v_add_u32 v2, s8, v234
  v_lshlrev_b32 v2, 2, v2
  v_add_u32 v2, 155648, v2
  ds_read_b32 v124, v2 offset:768
  ds_read_b32 v125, v2 offset:832
  ds_read_b32 v126, v2 offset:896
  ds_read_b32 v127, v2 offset:960
  ds_read_b32 v128, v2 offset:1024
  s_waitcnt lgkmcnt(0)
  v_fma_f32 v56, v156, v124, v196
  v_fma_f32 v57, v157, v125, v204
  v_fma_f32 v58, v158, v126, v212
  v_fma_f32 v59, v159, v127, v220
  v_fma_f32 v60, v160, v128, v228
  v_fmac_f32_dpp v56, v124, v161 row_ror:8 row_mask:0xf bank_mask:0xf
  v_fmac_f32_dpp v57, v125, v162 row_ror:8 row_mask:0xf bank_mask:0xf
  v_fmac_f32_dpp v58, v126, v163 row_ror:8 row_mask:0xf bank_mask:0xf
  v_fmac_f32_dpp v59, v127, v96 row_ror:8 row_mask:0xf bank_mask:0xf
  v_fmac_f32_dpp v60, v128, v97 row_ror:8 row_mask:0xf bank_mask:0xf
  v_mul_f32 v61, v194, v56
  v_mul_f32 v62, v202, v57
  v_mul_f32 v63, v210, v58
  v_mul_f32 v98, v218, v59
  v_mul_f32 v99, v226, v60
  v_fmac_f32_dpp v61, v56, v195 row_ror:8 row_mask:0xf bank_mask:0xf
  v_fmac_f32_dpp v62, v57, v203 row_ror:8 row_mask:0xf bank_mask:0xf
  v_fmac_f32_dpp v63, v58, v211 row_ror:8 row_mask:0xf bank_mask:0xf
  v_fmac_f32_dpp v98, v59, v219 row_ror:8 row_mask:0xf bank_mask:0xf
  v_fmac_f32_dpp v99, v60, v227 row_ror:8 row_mask:0xf bank_mask:0xf
  v_add_f32 v16, v16, v61
  v_add_f32 v24, v24, v62
  v_add_f32 v32, v32, v63
  v_add_f32 v40, v40, v98
  v_add_f32 v48, v48, v99
  v_mul_f32 v56, v194, v61
  v_mul_f32 v57, v202, v62
  v_mul_f32 v58, v210, v63
  v_mul_f32 v59, v218, v98
  v_mul_f32 v60, v226, v99
  v_fmac_f32_dpp v56, v61, v195 row_ror:8 row_mask:0xf bank_mask:0xf
  v_fmac_f32_dpp v57, v62, v203 row_ror:8 row_mask:0xf bank_mask:0xf
  v_fmac_f32_dpp v58, v63, v211 row_ror:8 row_mask:0xf bank_mask:0xf
  v_fmac_f32_dpp v59, v98, v219 row_ror:8 row_mask:0xf bank_mask:0xf
  v_fmac_f32_dpp v60, v99, v227 row_ror:8 row_mask:0xf bank_mask:0xf
  v_add_f32 v17, v17, v56
  v_add_f32 v25, v25, v57
  v_add_f32 v33, v33, v58
  v_add_f32 v41, v41, v59
  v_add_f32 v49, v49, v60
  v_mul_f32 v61, v194, v56
  v_mul_f32 v62, v202, v57
  v_mul_f32 v63, v210, v58
  v_mul_f32 v98, v218, v59
  v_mul_f32 v99, v226, v60
  v_fmac_f32_dpp v61, v56, v195 row_ror:8 row_mask:0xf bank_mask:0xf
  v_fmac_f32_dpp v62, v57, v203 row_ror:8 row_mask:0xf bank_mask:0xf
  v_fmac_f32_dpp v63, v58, v211 row_ror:8 row_mask:0xf bank_mask:0xf
  v_fmac_f32_dpp v98, v59, v219 row_ror:8 row_mask:0xf bank_mask:0xf
  v_fmac_f32_dpp v99, v60, v227 row_ror:8 row_mask:0xf bank_mask:0xf
  v_add_f32 v18, v18, v61
  v_add_f32 v26, v26, v62
  v_add_f32 v34, v34, v63
  v_add_f32 v42, v42, v98
  v_add_f32 v50, v50, v99
  v_mul_f32 v56, v194, v61
  v_mul_f32 v57, v202, v62
  v_mul_f32 v58, v210, v63
  v_mul_f32 v59, v218, v98
  v_mul_f32 v60, v226, v99
  v_fmac_f32_dpp v56, v61, v195 row_ror:8 row_mask:0xf bank_mask:0xf
  v_fmac_f32_dpp v57, v62, v203 row_ror:8 row_mask:0xf bank_mask:0xf
  v_fmac_f32_dpp v58, v63, v211 row_ror:8 row_mask:0xf bank_mask:0xf
  v_fmac_f32_dpp v59, v98, v219 row_ror:8 row_mask:0xf bank_mask:0xf
  v_fmac_f32_dpp v60, v99, v227 row_ror:8 row_mask:0xf bank_mask:0xf
  v_add_f32 v19, v19, v56
  v_add_f32 v27, v27, v57
  v_add_f32 v35, v35, v58
  v_add_f32 v43, v43, v59
  v_add_f32 v51, v51, v60
  v_mul_f32 v61, v194, v56
  v_mul_f32 v62, v202, v57
  v_mul_f32 v63, v210, v58
  v_mul_f32 v98, v218, v59
  v_mul_f32 v99, v226, v60
  v_fmac_f32_dpp v61, v56, v195 row_ror:8 row_mask:0xf bank_mask:0xf
  v_fmac_f32_dpp v62, v57, v203 row_ror:8 row_mask:0xf bank_mask:0xf
  v_fmac_f32_dpp v63, v58, v211 row_ror:8 row_mask:0xf bank_mask:0xf
  v_fmac_f32_dpp v98, v59, v219 row_ror:8 row_mask:0xf bank_mask:0xf
  v_fmac_f32_dpp v99, v60, v227 row_ror:8 row_mask:0xf bank_mask:0xf
  v_add_f32 v20, v20, v61
  v_add_f32 v28, v28, v62
  v_add_f32 v36, v36, v63
  v_add_f32 v44, v44, v98
  v_add_f32 v52, v52, v99
  v_mul_f32 v56, v194, v61
  v_mul_f32 v57, v202, v62
  v_mul_f32 v58, v210, v63
  v_mul_f32 v59, v218, v98
  v_mul_f32 v60, v226, v99
  v_fmac_f32_dpp v56, v61, v195 row_ror:8 row_mask:0xf bank_mask:0xf
  v_fmac_f32_dpp v57, v62, v203 row_ror:8 row_mask:0xf bank_mask:0xf
  v_fmac_f32_dpp v58, v63, v211 row_ror:8 row_mask:0xf bank_mask:0xf
  v_fmac_f32_dpp v59, v98, v219 row_ror:8 row_mask:0xf bank_mask:0xf
  v_fmac_f32_dpp v60, v99, v227 row_ror:8 row_mask:0xf bank_mask:0xf
  v_add_f32 v21, v21, v56
  v_add_f32 v29, v29, v57
  v_add_f32 v37, v37, v58
  v_add_f32 v45, v45, v59
  v_add_f32 v53, v53, v60
  v_mul_f32 v61, v194, v56
  v_mul_f32 v62, v202, v57
  v_mul_f32 v63, v210, v58
  v_mul_f32 v98, v218, v59
  v_mul_f32 v99, v226, v60
  v_fmac_f32_dpp v61, v56, v195 row_ror:8 row_mask:0xf bank_mask:0xf
  v_fmac_f32_dpp v62, v57, v203 row_ror:8 row_mask:0xf bank_mask:0xf
  v_fmac_f32_dpp v63, v58, v211 row_ror:8 row_mask:0xf bank_mask:0xf
  v_fmac_f32_dpp v98, v59, v219 row_ror:8 row_mask:0xf bank_mask:0xf
  v_fmac_f32_dpp v99, v60, v227 row_ror:8 row_mask:0xf bank_mask:0xf
  v_add_f32 v22, v22, v61
  v_add_f32 v30, v30, v62
  v_add_f32 v38, v38, v63
  v_add_f32 v46, v46, v98
  v_add_f32 v54, v54, v99
  v_mul_f32 v56, v194, v61
  v_mul_f32 v57, v202, v62
  v_mul_f32 v58, v210, v63
  v_mul_f32 v59, v218, v98
  v_mul_f32 v60, v226, v99
  v_fmac_f32_dpp v56, v61, v195 row_ror:8 row_mask:0xf bank_mask:0xf
  v_fmac_f32_dpp v57, v62, v203 row_ror:8 row_mask:0xf bank_mask:0xf
  v_fmac_f32_dpp v58, v63, v211 row_ror:8 row_mask:0xf bank_mask:0xf
  v_fmac_f32_dpp v59, v98, v219 row_ror:8 row_mask:0xf bank_mask:0xf
  v_fmac_f32_dpp v60, v99, v227 row_ror:8 row_mask:0xf bank_mask:0xf
  v_add_f32 v23, v23, v56
  v_add_f32 v31, v31, v57
  v_add_f32 v39, v39, v58
  v_add_f32 v47, v47, v59
  v_add_f32 v55, v55, v60
  s_and_b32 s8, s51, 1
  s_mul_i32 s8, s8, 40
  s_mul_i32 s9, s4, 80
  s_add_u32 s8, s8, s9
  v_lshrrev_b32 v2, 3, v234
  v_mul_u32_u24 v2, 640, v2
  v_and_b32 v3, 7, v234
  v_add3_u32 v2, v2, v3, s8
  s_lshr_b32 s9, s51, 1
  s_lshl_b32 s9, s9, 2
  v_add_u32 v3, s9, v235
  s_mul_i32 s10, s5, 163840
  s_add_u32 s10, s10, 7340032
  v_mul_f32 v124, v200, v16
  v_mul_f32 v125, v200, v17
  v_mul_f32 v126, v200, v18
  v_mul_f32 v127, v200, v19
  v_mul_f32 v128, v200, v20
  v_mul_f32 v129, v200, v21
  v_mul_f32 v130, v200, v22
  v_mul_f32 v131, v200, v23
  v_fmac_f32_dpp v124, v16, v201 row_ror:8 row_mask:0xf bank_mask:0xf
  v_fmac_f32_dpp v125, v17, v201 row_ror:8 row_mask:0xf bank_mask:0xf
  v_fmac_f32_dpp v126, v18, v201 row_ror:8 row_mask:0xf bank_mask:0xf
  v_fmac_f32_dpp v127, v19, v201 row_ror:8 row_mask:0xf bank_mask:0xf
  v_fmac_f32_dpp v128, v20, v201 row_ror:8 row_mask:0xf bank_mask:0xf
  v_fmac_f32_dpp v129, v21, v201 row_ror:8 row_mask:0xf bank_mask:0xf
  v_fmac_f32_dpp v130, v22, v201 row_ror:8 row_mask:0xf bank_mask:0xf
  v_fmac_f32_dpp v131, v23, v201 row_ror:8 row_mask:0xf bank_mask:0xf
  v_cvt_pk_bf16_f32 v184, v124, v125
  v_cvt_pk_bf16_f32 v185, v126, v127
  v_cvt_pk_bf16_f32 v186, v128, v129
  v_cvt_pk_bf16_f32 v187, v130, v131
  v_add_u32 v4, 0, v2
  v_and_b32 v5, 0x13, v4
  v_and_b32 v6, 4, v4
  v_lshlrev_b32 v6, 1, v6
  v_or_b32 v5, v5, v6
  v_and_b32 v6, 8, v4
  v_lshrrev_b32 v6, 1, v6
  v_or_b32 v5, v5, v6
  v_and_b32 v6, 6, v5
  v_xor_b32 v6, v6, v3
  v_and_b32 v4, 0xffffffe0, v4
  v_or_b32 v4, v4, v5
  v_lshlrev_b32 v4, 7, v4
  v_lshl_add_u32 v4, v6, 4, v4
  buffer_store_dwordx4 v[184:187], v4, s[52:55], s10 offen
  v_mul_f32 v124, v208, v24
  v_mul_f32 v125, v208, v25
  v_mul_f32 v126, v208, v26
  v_mul_f32 v127, v208, v27
  v_mul_f32 v128, v208, v28
  v_mul_f32 v129, v208, v29
  v_mul_f32 v130, v208, v30
  v_mul_f32 v131, v208, v31
  v_fmac_f32_dpp v124, v24, v209 row_ror:8 row_mask:0xf bank_mask:0xf
  v_fmac_f32_dpp v125, v25, v209 row_ror:8 row_mask:0xf bank_mask:0xf
  v_fmac_f32_dpp v126, v26, v209 row_ror:8 row_mask:0xf bank_mask:0xf
  v_fmac_f32_dpp v127, v27, v209 row_ror:8 row_mask:0xf bank_mask:0xf
  v_fmac_f32_dpp v128, v28, v209 row_ror:8 row_mask:0xf bank_mask:0xf
  v_fmac_f32_dpp v129, v29, v209 row_ror:8 row_mask:0xf bank_mask:0xf
  v_fmac_f32_dpp v130, v30, v209 row_ror:8 row_mask:0xf bank_mask:0xf
  v_fmac_f32_dpp v131, v31, v209 row_ror:8 row_mask:0xf bank_mask:0xf
  v_cvt_pk_bf16_f32 v188, v124, v125
  v_cvt_pk_bf16_f32 v189, v126, v127
  v_cvt_pk_bf16_f32 v190, v128, v129
  v_cvt_pk_bf16_f32 v191, v130, v131
  v_add_u32 v4, 8, v2
  v_and_b32 v5, 0x13, v4
  v_and_b32 v6, 4, v4
  v_lshlrev_b32 v6, 1, v6
  v_or_b32 v5, v5, v6
  v_and_b32 v6, 8, v4
  v_lshrrev_b32 v6, 1, v6
  v_or_b32 v5, v5, v6
  v_and_b32 v6, 6, v5
  v_xor_b32 v6, v6, v3
  v_and_b32 v4, 0xffffffe0, v4
  v_or_b32 v4, v4, v5
  v_lshlrev_b32 v4, 7, v4
  v_lshl_add_u32 v4, v6, 4, v4
  buffer_store_dwordx4 v[188:191], v4, s[52:55], s10 offen
  v_mul_f32 v124, v216, v32
  v_mul_f32 v125, v216, v33
  v_mul_f32 v126, v216, v34
  v_mul_f32 v127, v216, v35
  v_mul_f32 v128, v216, v36
  v_mul_f32 v129, v216, v37
  v_mul_f32 v130, v216, v38
  v_mul_f32 v131, v216, v39
  v_fmac_f32_dpp v124, v32, v217 row_ror:8 row_mask:0xf bank_mask:0xf
  v_fmac_f32_dpp v125, v33, v217 row_ror:8 row_mask:0xf bank_mask:0xf
  v_fmac_f32_dpp v126, v34, v217 row_ror:8 row_mask:0xf bank_mask:0xf
  v_fmac_f32_dpp v127, v35, v217 row_ror:8 row_mask:0xf bank_mask:0xf
  v_fmac_f32_dpp v128, v36, v217 row_ror:8 row_mask:0xf bank_mask:0xf
  v_fmac_f32_dpp v129, v37, v217 row_ror:8 row_mask:0xf bank_mask:0xf
  v_fmac_f32_dpp v130, v38, v217 row_ror:8 row_mask:0xf bank_mask:0xf
  v_fmac_f32_dpp v131, v39, v217 row_ror:8 row_mask:0xf bank_mask:0xf
  v_cvt_pk_bf16_f32 v184, v124, v125
  v_cvt_pk_bf16_f32 v185, v126, v127
  v_cvt_pk_bf16_f32 v186, v128, v129
  v_cvt_pk_bf16_f32 v187, v130, v131
  v_add_u32 v4, 16, v2
  v_and_b32 v5, 0x13, v4
  v_and_b32 v6, 4, v4
  v_lshlrev_b32 v6, 1, v6
  v_or_b32 v5, v5, v6
  v_and_b32 v6, 8, v4
  v_lshrrev_b32 v6, 1, v6
  v_or_b32 v5, v5, v6
  v_and_b32 v6, 6, v5
  v_xor_b32 v6, v6, v3
  v_and_b32 v4, 0xffffffe0, v4
  v_or_b32 v4, v4, v5
  v_lshlrev_b32 v4, 7, v4
  v_lshl_add_u32 v4, v6, 4, v4
  buffer_store_dwordx4 v[184:187], v4, s[52:55], s10 offen
  v_mul_f32 v124, v224, v40
  v_mul_f32 v125, v224, v41
  v_mul_f32 v126, v224, v42
  v_mul_f32 v127, v224, v43
  v_mul_f32 v128, v224, v44
  v_mul_f32 v129, v224, v45
  v_mul_f32 v130, v224, v46
  v_mul_f32 v131, v224, v47
  v_fmac_f32_dpp v124, v40, v225 row_ror:8 row_mask:0xf bank_mask:0xf
  v_fmac_f32_dpp v125, v41, v225 row_ror:8 row_mask:0xf bank_mask:0xf
  v_fmac_f32_dpp v126, v42, v225 row_ror:8 row_mask:0xf bank_mask:0xf
  v_fmac_f32_dpp v127, v43, v225 row_ror:8 row_mask:0xf bank_mask:0xf
  v_fmac_f32_dpp v128, v44, v225 row_ror:8 row_mask:0xf bank_mask:0xf
  v_fmac_f32_dpp v129, v45, v225 row_ror:8 row_mask:0xf bank_mask:0xf
  v_fmac_f32_dpp v130, v46, v225 row_ror:8 row_mask:0xf bank_mask:0xf
  v_fmac_f32_dpp v131, v47, v225 row_ror:8 row_mask:0xf bank_mask:0xf
  v_cvt_pk_bf16_f32 v188, v124, v125
  v_cvt_pk_bf16_f32 v189, v126, v127
  v_cvt_pk_bf16_f32 v190, v128, v129
  v_cvt_pk_bf16_f32 v191, v130, v131
  v_add_u32 v4, 24, v2
  v_and_b32 v5, 0x13, v4
  v_and_b32 v6, 4, v4
  v_lshlrev_b32 v6, 1, v6
  v_or_b32 v5, v5, v6
  v_and_b32 v6, 8, v4
  v_lshrrev_b32 v6, 1, v6
  v_or_b32 v5, v5, v6
  v_and_b32 v6, 6, v5
  v_xor_b32 v6, v6, v3
  v_and_b32 v4, 0xffffffe0, v4
  v_or_b32 v4, v4, v5
  v_lshlrev_b32 v4, 7, v4
  v_lshl_add_u32 v4, v6, 4, v4
  buffer_store_dwordx4 v[188:191], v4, s[52:55], s10 offen
  v_mul_f32 v124, v232, v48
  v_mul_f32 v125, v232, v49
  v_mul_f32 v126, v232, v50
  v_mul_f32 v127, v232, v51
  v_mul_f32 v128, v232, v52
  v_mul_f32 v129, v232, v53
  v_mul_f32 v130, v232, v54
  v_mul_f32 v131, v232, v55
  v_fmac_f32_dpp v124, v48, v233 row_ror:8 row_mask:0xf bank_mask:0xf
  v_fmac_f32_dpp v125, v49, v233 row_ror:8 row_mask:0xf bank_mask:0xf
  v_fmac_f32_dpp v126, v50, v233 row_ror:8 row_mask:0xf bank_mask:0xf
  v_fmac_f32_dpp v127, v51, v233 row_ror:8 row_mask:0xf bank_mask:0xf
  v_fmac_f32_dpp v128, v52, v233 row_ror:8 row_mask:0xf bank_mask:0xf
  v_fmac_f32_dpp v129, v53, v233 row_ror:8 row_mask:0xf bank_mask:0xf
  v_fmac_f32_dpp v130, v54, v233 row_ror:8 row_mask:0xf bank_mask:0xf
  v_fmac_f32_dpp v131, v55, v233 row_ror:8 row_mask:0xf bank_mask:0xf
  v_cvt_pk_bf16_f32 v184, v124, v125
  v_cvt_pk_bf16_f32 v185, v126, v127
  v_cvt_pk_bf16_f32 v186, v128, v129
  v_cvt_pk_bf16_f32 v187, v130, v131
  v_add_u32 v4, 32, v2
  v_and_b32 v5, 0x13, v4
  v_and_b32 v6, 4, v4
  v_lshlrev_b32 v6, 1, v6
  v_or_b32 v5, v5, v6
  v_and_b32 v6, 8, v4
  v_lshrrev_b32 v6, 1, v6
  v_or_b32 v5, v5, v6
  v_and_b32 v6, 6, v5
  v_xor_b32 v6, v6, v3
  v_and_b32 v4, 0xffffffe0, v4
  v_or_b32 v4, v4, v5
  v_lshlrev_b32 v4, 7, v4
  v_lshl_add_u32 v4, v6, 4, v4
  buffer_store_dwordx4 v[184:187], v4, s[52:55], s10 offen
  s_waitcnt vmcnt(5)
  s_lshl_b32 s9, s5, 13
  s_add_u32 s9, s9, 655360
  s_mov_b32 s12, 0
  s_branch L_s3chk1
L_s3chk:
  buffer_load_dwordx4 v[100:103], v87, s[52:55], s9 offen offset:0 sc1
  buffer_load_dwordx4 v[104:107], v87, s[52:55], s9 offen offset:16 sc1
  buffer_load_dwordx4 v[108:111], v87, s[52:55], s9 offen offset:2048 sc1
  buffer_load_dwordx4 v[112:115], v87, s[52:55], s9 offen offset:2064 sc1
  s_waitcnt vmcnt(0)
L_s3chk1:
  v_cmp_ne_u32 s[96:97], s7, v101
  v_cmp_ne_u32 vcc, s7, v103
  s_nop 3
  s_or_b64 s[96:97], s[96:97], vcc
  v_cmp_ne_u32 vcc, s7, v105
  s_nop 3
  s_or_b64 s[96:97], s[96:97], vcc
  v_cmp_ne_u32 vcc, s7, v107
  s_nop 3
  s_or_b64 s[96:97], s[96:97], vcc
  v_cmp_ne_u32 vcc, s7, v109
  s_nop 3
  s_or_b64 s[96:97], s[96:97], vcc
  v_cmp_ne_u32 vcc, s7, v111
  s_nop 3
  s_or_b64 s[96:97], s[96:97], vcc
  v_cmp_ne_u32 vcc, s7, v113
  s_nop 3
  s_or_b64 s[96:97], s[96:97], vcc
  v_cmp_ne_u32 vcc, s7, v115
  s_nop 3
  s_or_b64 s[96:97], s[96:97], vcc
  s_add_u32 s12, s12, 1
  s_cmp_eq_u64 s[96:97], 0
  s_cbranch_scc1 L_s3ok
  s_cmp_lt_u32 s12, 0x8000
  s_cbranch_scc1 L_s3chk
L_s3ok:
  v_add_f32 v100, v100, v104
  v_add_f32 v102, v102, v106
  v_mov_b32 v101, v100
  s_nop 1
  v_permlane16_swap_b32 v100, v101
  v_add_f32 v100, v100, v101
  v_mov_b32 v101, v100
  s_nop 1
  v_permlane32_swap_b32 v100, v101
  v_add_f32 v100, v100, v101
  v_mov_b32 v103, v102
  s_nop 1
  v_permlane16_swap_b32 v102, v103
  v_add_f32 v102, v102, v103
  v_mov_b32 v103, v102
  s_nop 1
  v_permlane32_swap_b32 v102, v103
  v_add_f32 v102, v102, v103
  v_mul_f32 v100, 0x3acccccd, v100
  v_mul_f32 v102, 0x3acccccd, v102
  v_fma_f32 v102, -v100, v100, v102
  v_max_f32 v102, 0, v102
  v_add_f32 v102, 0x3727c5ac, v102
  v_rsq_f32 v88, v102
  s_nop 0
  v_mul_f32 v90, v100, v88
  v_sub_f32 v90, 0, v90
  v_mov_b32 v89, v88
  v_mov_b32 v91, v90
  v_add_f32 v108, v108, v112
  v_add_f32 v110, v110, v114
  v_mov_b32 v109, v108
  s_nop 1
  v_permlane16_swap_b32 v108, v109
  v_add_f32 v108, v108, v109
  v_mov_b32 v109, v108
  s_nop 1
  v_permlane32_swap_b32 v108, v109
  v_add_f32 v108, v108, v109
  v_mov_b32 v111, v110
  s_nop 1
  v_permlane16_swap_b32 v110, v111
  v_add_f32 v110, v110, v111
  v_mov_b32 v111, v110
  s_nop 1
  v_permlane32_swap_b32 v110, v111
  v_add_f32 v110, v110, v111
  v_mul_f32 v108, 0x3acccccd, v108
  v_mul_f32 v110, 0x3acccccd, v110
  v_fma_f32 v110, -v108, v108, v110
  v_max_f32 v110, 0, v110
  v_add_f32 v110, 0x3727c5ac, v110
  v_rsq_f32 v92, v110
  s_nop 0
  v_mul_f32 v94, v108, v92
  v_sub_f32 v94, 0, v94
  v_mov_b32 v93, v92
  v_mov_b32 v95, v94
  v_mov_b32 v6, s14
  v_mov_b32 v7, s14
  v_mov_b32 v8, s14
  v_mov_b32 v9, s14
  v_mov_b32 v16, 0
  v_mov_b32 v17, 0
  v_mov_b32 v18, 0
  v_mov_b32 v19, 0
  v_mov_b32 v20, 0
  v_mov_b32 v21, 0
  v_mov_b32 v22, 0
  v_mov_b32 v23, 0
  v_mov_b32 v24, 0
  v_mov_b32 v25, 0
  v_mov_b32 v26, 0
  v_mov_b32 v27, 0
  v_mov_b32 v28, 0
  v_mov_b32 v29, 0
  v_mov_b32 v30, 0
  v_mov_b32 v31, 0
  v_mov_b32 v32, 0
  v_mov_b32 v33, 0
  v_mov_b32 v34, 0
  v_mov_b32 v35, 0
  v_mov_b32 v36, 0
  v_mov_b32 v37, 0
  v_mov_b32 v38, 0
  v_mov_b32 v39, 0
  v_mov_b32 v40, 0
  v_mov_b32 v41, 0
  v_mov_b32 v42, 0
  v_mov_b32 v43, 0
  v_mov_b32 v44, 0
  v_mov_b32 v45, 0
  v_mov_b32 v46, 0
  v_mov_b32 v47, 0
  v_mov_b32 v48, 0
  v_mov_b32 v49, 0
  v_mov_b32 v50, 0
  v_mov_b32 v51, 0
  v_mov_b32 v52, 0
  v_mov_b32 v53, 0
  v_mov_b32 v54, 0
  v_mov_b32 v55, 0
  v_mov_b32 v56, 0
  v_mov_b32 v57, 0
  v_mov_b32 v58, 0
  v_mov_b32 v59, 0
  v_mov_b32 v60, 0
  v_mov_b32 v61, 0
  v_mov_b32 v62, 0
  v_mov_b32 v63, 0
  v_mov_b32 v76, 0
  v_mov_b32 v77, 0
  v_mov_b32 v78, 0
  v_mov_b32 v79, 0
  v_mov_b32 v80, 0
  v_mov_b32 v81, 0
  v_mov_b32 v82, 0
  v_mov_b32 v83, 0
  v_mov_b32 v84, 0
  v_mov_b32 v85, 0
  v_mov_b32 v86, 0
  v_mov_b32 v87, 0
  v_mov_b32 v132, 0
  v_mov_b32 v133, 0
  v_mov_b32 v134, 0
  v_mov_b32 v135, 0
  v_mov_b32 v136, 0
  v_mov_b32 v137, 0
  v_mov_b32 v138, 0
  v_mov_b32 v139, 0
  v_mov_b32 v140, 0
  v_mov_b32 v141, 0
  v_mov_b32 v142, 0
  v_mov_b32 v143, 0
  v_mov_b32 v144, 0
  v_mov_b32 v145, 0
  v_mov_b32 v146, 0
  v_mov_b32 v147, 0
  v_mov_b32 v148, 0
  v_mov_b32 v149, 0
  v_mov_b32 v150, 0
  v_mov_b32 v151, 0
  v_mov_b32 v152, 0
  v_mov_b32 v153, 0
  v_mov_b32 v154, 0
  v_mov_b32 v155, 0
  v_mov_b32 v156, 0
  v_mov_b32 v157, 0
  v_mov_b32 v158, 0
  v_mov_b32 v159, 0
  v_mov_b32 v160, 0
  v_mov_b32 v161, 0
  v_mov_b32 v162, 0
  v_mov_b32 v163, 0
  s_mul_i32 s8, s4, 24576
  s_mul_i32 s9, s5, 196608
  s_add_u32 s8, s8, s9
  s_add_u32 s8, s8, 13631488
  s_mul_i32 s9, s51, 5
  v_add_u32 v98, s9, v0
  v_lshlrev_b32 v98, 7, v98
  v_add_u32 v98, s8, v98
  v_mov_b32 v2, 2147483632
  v_cmp_gt_u32 vcc, 5, v0
  s_cmp_eq_u32 s100, 1
  s_nop 2
  s_cselect_b64 vcc, vcc, 0
  v_cndmask_b32 v98, v2, v98, vcc
  s_mov_b32 s101, 2
  s_call_b64 s[30:31], L_t3sub
  s_waitcnt vmcnt(0)
  s_cmp_eq_u32 s100, 1
  s_cbranch_scc1 L_pubf3
  s_waitcnt vmcnt(0)
  buffer_wbl2 sc1
  s_waitcnt vmcnt(0)
L_pubf3:
  s_lshl_b32 s8, s5, 3
  s_add_u32 s8, s8, s4
  s_lshl_b32 s8, s8, 7
  s_lshl_b32 s9, s51, 2
  s_add_u32 s8, s8, s9
  s_add_u32 s8, s8, 131072
  v_mov_b32 v2, s7
  v_mov_b32 v3, 0
  s_mov_b64 exec, 1
  s_cmp_eq_u32 s100, 1
  s_cbranch_scc1 L_pubg3
  buffer_store_dword v2, v3, s[52:55], s8 offen sc1
  s_branch L_pubh3
L_pubg3:
  buffer_store_dword v2, v3, s[52:55], s8 offen
L_pubh3:
  s_mov_b64 exec, -1
  s_mov_b32 s101, 8
  s_call_b64 s[30:31], L_t3sub
  v_mfma_f32_16x16x32_bf16 v[16:19], v[140:143], v[132:135], v[16:19]
  v_mfma_f32_16x16x32_bf16 v[20:23], v[140:143], v[136:139], v[20:23]
  v_mfma_f32_16x16x32_bf16 v[76:79], v[140:143], v[6:9], v[76:79]
  v_mfma_f32_16x16x32_bf16 v[24:27], v[144:147], v[132:135], v[24:27]
  v_mfma_f32_16x16x32_bf16 v[28:31], v[144:147], v[136:139], v[28:31]
  v_mfma_f32_16x16x32_bf16 v[80:83], v[144:147], v[6:9], v[80:83]
  v_mfma_f32_16x16x32_bf16 v[32:35], v[148:151], v[132:135], v[32:35]
  v_mfma_f32_16x16x32_bf16 v[36:39], v[148:151], v[136:139], v[36:39]
  v_mfma_f32_16x16x32_bf16 v[84:87], v[148:151], v[6:9], v[84:87]
  v_mfma_f32_16x16x32_bf16 v[40:43], v[152:155], v[132:135], v[40:43]
  v_mfma_f32_16x16x32_bf16 v[44:47], v[152:155], v[136:139], v[44:47]
  v_mfma_f32_16x16x32_bf16 v[48:51], v[156:159], v[132:135], v[48:51]
  v_mfma_f32_16x16x32_bf16 v[52:55], v[156:159], v[136:139], v[52:55]
  v_mfma_f32_16x16x32_bf16 v[56:59], v[160:163], v[132:135], v[56:59]
  v_mfma_f32_16x16x32_bf16 v[60:63], v[160:163], v[136:139], v[60:63]
  s_barrier
  s_and_b32 s8, s51, 1
  s_mul_i32 s8, s8, 384
  s_lshr_b32 s9, s51, 1
  s_mul_i32 s9, s9, 192
  v_lshl_add_u32 v11, v235, 4, s8
  v_add_u32 v11, 155648, v11
  v_add_u32 v3, s9, v11
  s_mov_b32 exec_lo, 0x00010001
  s_mov_b32 exec_hi, 0x00010001
  ds_write_b128 v3, v[76:79] offset:1536
  ds_write_b128 v3, v[80:83] offset:1600
  ds_write_b128 v3, v[84:87] offset:1664
  s_mov_b64 exec, -1
  v_mov_b32 v2, 157060
  s_waitcnt lgkmcnt(0)
  v_mov_b32 v3, 1
  s_mov_b64 exec, 1
  ds_add_u32 v2, v3
  s_mov_b64 exec, -1
  s_mov_b32 s12, 0
L_spin2:
  ds_read_b32 v3, v2
  s_add_u32 s12, s12, 1
  s_waitcnt lgkmcnt(0)
  v_readfirstlane_b32 s11, v3
  s_nop 3
  s_cmp_ge_u32 s11, 4
  s_cbranch_scc1 L_spind2
  s_cmp_lt_u32 s12, 0x100000
  s_cbranch_scc1 L_spin2
L_spind2:
  s_lshr_b32 s9, s51, 1
  s_mul_i32 s9, s9, 192
  v_add_u32 v10, s9, v11
  v_subrev_u32 v3, s9, v11
  ds_read_b128 v[112:115], v10 offset:1536
  ds_read_b128 v[116:119], v10 offset:1600
  ds_read_b128 v[120:123], v10 offset:1664
  ds_read_b128 v[124:127], v3 offset:1728
  ds_read_b128 v[128:131], v3 offset:1792
  ds_read_b128 v[132:135], v3 offset:1856
  v_mov_b32 v104, 0xbdd2d3e8
  v_mov_b32 v105, 0xbdd2d3e8
  v_mov_b32 v106, 0xc0135761
  v_mov_b32 v107, 0xc0135761
  v_mov_b32 v108, 1.0
  v_mov_b32 v109, 1.0
  s_mul_i32 s8, s4, 24
  s_and_b32 s9, s51, 1
  s_mul_i32 s9, s9, 12
  s_add_u32 s8, s8, s9
  s_lshr_b32 s9, s51, 1
  s_mul_i32 s11, s9, 3
  v_and_b32 v2, 1, v235
  v_add_u32 v2, s11, v2
  s_lshl_b32 s9, s9, 5
  v_add_u32 v12, s9, v234
  v_lshlrev_b32 v12, 7, v12
  v_and_b32 v4, 2, v234
  v_lshrrev_b32 v5, 1, v234
  v_and_b32 v5, 4, v5
  v_or_b32 v4, v4, v5
  v_lshrrev_b32 v13, 1, v235
  v_add_u32 v13, s8, v13
  s_mul_i32 s10, s5, 196608
  s_add_u32 s10, s10, 13631488
  v_add_u32 v5, 0, v2
  v_subrev_u32 v6, 6, v5
  v_min_u32 v5, v5, v6
  v_lshl_add_u32 v5, v5, 1, v13
  v_lshrrev_b32 v6, 3, v5
  v_and_b32 v5, 7, v5
  v_xor_b32 v5, v5, v4
  v_lshlrev_b32 v5, 4, v5
  v_lshl_add_u32 v5, v6, 13, v5
  v_add_u32 v7, v5, v12
  v_add_u32 v5, 2, v2
  v_subrev_u32 v6, 6, v5
  v_min_u32 v5, v5, v6
  v_lshl_add_u32 v5, v5, 1, v13
  v_lshrrev_b32 v6, 3, v5
  v_and_b32 v5, 7, v5
  v_xor_b32 v5, v5, v4
  v_lshlrev_b32 v5, 4, v5
  v_lshl_add_u32 v5, v6, 13, v5
  v_add_u32 v8, v5, v12
  v_add_u32 v5, 4, v2
  v_subrev_u32 v6, 6, v5
  v_min_u32 v5, v5, v6
  v_lshl_add_u32 v5, v5, 1, v13
  v_lshrrev_b32 v6, 3, v5
  v_and_b32 v5, 7, v5
  v_xor_b32 v5, v5, v4
  v_lshlrev_b32 v5, 4, v5
  v_lshl_add_u32 v5, v6, 13, v5
  v_add_u32 v9, v5, v12
  s_waitcnt lgkmcnt(0)
  v_pk_mul_f32 v[16:17], v[16:17], v[88:89]
  v_pk_fma_f32 v[16:17], v[112:113], v[90:91], v[16:17]
  v_pk_mul_f32 v[18:19], v[18:19], v[88:89]
  v_pk_fma_f32 v[18:19], v[114:115], v[90:91], v[18:19]
  v_pk_mul_f32 v[100:101], v[16:17], v[16:17]
  v_pk_mul_f32 v[102:103], v[18:19], v[18:19]
  v_pk_fma_f32 v[100:101], v[100:101], v[104:105], v[106:107]
  v_pk_fma_f32 v[102:103], v[102:103], v[104:105], v[106:107]
  v_pk_mul_f32 v[100:101], v[100:101], v[16:17]
  v_pk_mul_f32 v[102:103], v[102:103], v[18:19]
  v_exp_f32 v100, v100
  v_exp_f32 v101, v101
  v_exp_f32 v102, v102
  v_exp_f32 v103, v103
  v_pk_add_f32 v[100:101], v[100:101], v[108:109]
  v_pk_add_f32 v[102:103], v[102:103], v[108:109]
  v_rcp_f32 v100, v100
  v_rcp_f32 v101, v101
  v_rcp_f32 v102, v102
  v_rcp_f32 v103, v103
  v_pk_mul_f32 v[16:17], v[16:17], v[100:101]
  v_pk_mul_f32 v[18:19], v[18:19], v[102:103]
  v_cvt_pk_bf16_f32 v136, v16, v17
  v_cvt_pk_bf16_f32 v137, v18, v19
  v_pk_mul_f32 v[24:25], v[24:25], v[88:89]
  v_pk_fma_f32 v[24:25], v[116:117], v[90:91], v[24:25]
  v_pk_mul_f32 v[26:27], v[26:27], v[88:89]
  v_pk_fma_f32 v[26:27], v[118:119], v[90:91], v[26:27]
  v_pk_mul_f32 v[100:101], v[24:25], v[24:25]
  v_pk_mul_f32 v[102:103], v[26:27], v[26:27]
  v_pk_fma_f32 v[100:101], v[100:101], v[104:105], v[106:107]
  v_pk_fma_f32 v[102:103], v[102:103], v[104:105], v[106:107]
  v_pk_mul_f32 v[100:101], v[100:101], v[24:25]
  v_pk_mul_f32 v[102:103], v[102:103], v[26:27]
  v_exp_f32 v100, v100
  v_exp_f32 v101, v101
  v_exp_f32 v102, v102
  v_exp_f32 v103, v103
  v_pk_add_f32 v[100:101], v[100:101], v[108:109]
  v_pk_add_f32 v[102:103], v[102:103], v[108:109]
  v_rcp_f32 v100, v100
  v_rcp_f32 v101, v101
  v_rcp_f32 v102, v102
  v_rcp_f32 v103, v103
  v_pk_mul_f32 v[24:25], v[24:25], v[100:101]
  v_pk_mul_f32 v[26:27], v[26:27], v[102:103]
  v_cvt_pk_bf16_f32 v138, v24, v25
  v_cvt_pk_bf16_f32 v139, v26, v27
  s_nop 0
  v_permlane16_swap_b32 v136, v138
  v_permlane16_swap_b32 v137, v139
  buffer_store_dwordx4 v[136:139], v7, s[52:55], s10 offen offset:0
  v_pk_mul_f32 v[20:21], v[20:21], v[92:93]
  v_pk_fma_f32 v[20:21], v[112:113], v[94:95], v[20:21]
  v_pk_mul_f32 v[22:23], v[22:23], v[92:93]
  v_pk_fma_f32 v[22:23], v[114:115], v[94:95], v[22:23]
  v_pk_mul_f32 v[100:101], v[20:21], v[20:21]
  v_pk_mul_f32 v[102:103], v[22:23], v[22:23]
  v_pk_fma_f32 v[100:101], v[100:101], v[104:105], v[106:107]
  v_pk_fma_f32 v[102:103], v[102:103], v[104:105], v[106:107]
  v_pk_mul_f32 v[100:101], v[100:101], v[20:21]
  v_pk_mul_f32 v[102:103], v[102:103], v[22:23]
  v_exp_f32 v100, v100
  v_exp_f32 v101, v101
  v_exp_f32 v102, v102
  v_exp_f32 v103, v103
  v_pk_add_f32 v[100:101], v[100:101], v[108:109]
  v_pk_add_f32 v[102:103], v[102:103], v[108:109]
  v_rcp_f32 v100, v100
  v_rcp_f32 v101, v101
  v_rcp_f32 v102, v102
  v_rcp_f32 v103, v103
  v_pk_mul_f32 v[20:21], v[20:21], v[100:101]
  v_pk_mul_f32 v[22:23], v[22:23], v[102:103]
  v_cvt_pk_bf16_f32 v140, v20, v21
  v_cvt_pk_bf16_f32 v141, v22, v23
  v_pk_mul_f32 v[28:29], v[28:29], v[92:93]
  v_pk_fma_f32 v[28:29], v[116:117], v[94:95], v[28:29]
  v_pk_mul_f32 v[30:31], v[30:31], v[92:93]
  v_pk_fma_f32 v[30:31], v[118:119], v[94:95], v[30:31]
  v_pk_mul_f32 v[100:101], v[28:29], v[28:29]
  v_pk_mul_f32 v[102:103], v[30:31], v[30:31]
  v_pk_fma_f32 v[100:101], v[100:101], v[104:105], v[106:107]
  v_pk_fma_f32 v[102:103], v[102:103], v[104:105], v[106:107]
  v_pk_mul_f32 v[100:101], v[100:101], v[28:29]
  v_pk_mul_f32 v[102:103], v[102:103], v[30:31]
  v_exp_f32 v100, v100
  v_exp_f32 v101, v101
  v_exp_f32 v102, v102
  v_exp_f32 v103, v103
  v_pk_add_f32 v[100:101], v[100:101], v[108:109]
  v_pk_add_f32 v[102:103], v[102:103], v[108:109]
  v_rcp_f32 v100, v100
  v_rcp_f32 v101, v101
  v_rcp_f32 v102, v102
  v_rcp_f32 v103, v103
  v_pk_mul_f32 v[28:29], v[28:29], v[100:101]
  v_pk_mul_f32 v[30:31], v[30:31], v[102:103]
  v_cvt_pk_bf16_f32 v142, v28, v29
  v_cvt_pk_bf16_f32 v143, v30, v31
  s_nop 0
  v_permlane16_swap_b32 v140, v142
  v_permlane16_swap_b32 v141, v143
  buffer_store_dwordx4 v[140:143], v7, s[52:55], s10 offen offset:2048
  v_pk_mul_f32 v[32:33], v[32:33], v[88:89]
  v_pk_fma_f32 v[32:33], v[120:121], v[90:91], v[32:33]
  v_pk_mul_f32 v[34:35], v[34:35], v[88:89]
  v_pk_fma_f32 v[34:35], v[122:123], v[90:91], v[34:35]
  v_pk_mul_f32 v[100:101], v[32:33], v[32:33]
  v_pk_mul_f32 v[102:103], v[34:35], v[34:35]
  v_pk_fma_f32 v[100:101], v[100:101], v[104:105], v[106:107]
  v_pk_fma_f32 v[102:103], v[102:103], v[104:105], v[106:107]
  v_pk_mul_f32 v[100:101], v[100:101], v[32:33]
  v_pk_mul_f32 v[102:103], v[102:103], v[34:35]
  v_exp_f32 v100, v100
  v_exp_f32 v101, v101
  v_exp_f32 v102, v102
  v_exp_f32 v103, v103
  v_pk_add_f32 v[100:101], v[100:101], v[108:109]
  v_pk_add_f32 v[102:103], v[102:103], v[108:109]
  v_rcp_f32 v100, v100
  v_rcp_f32 v101, v101
  v_rcp_f32 v102, v102
  v_rcp_f32 v103, v103
  v_pk_mul_f32 v[32:33], v[32:33], v[100:101]
  v_pk_mul_f32 v[34:35], v[34:35], v[102:103]
  v_cvt_pk_bf16_f32 v144, v32, v33
  v_cvt_pk_bf16_f32 v145, v34, v35
  v_pk_mul_f32 v[40:41], v[40:41], v[88:89]
  v_pk_fma_f32 v[40:41], v[124:125], v[90:91], v[40:41]
  v_pk_mul_f32 v[42:43], v[42:43], v[88:89]
  v_pk_fma_f32 v[42:43], v[126:127], v[90:91], v[42:43]
  v_pk_mul_f32 v[100:101], v[40:41], v[40:41]
  v_pk_mul_f32 v[102:103], v[42:43], v[42:43]
  v_pk_fma_f32 v[100:101], v[100:101], v[104:105], v[106:107]
  v_pk_fma_f32 v[102:103], v[102:103], v[104:105], v[106:107]
  v_pk_mul_f32 v[100:101], v[100:101], v[40:41]
  v_pk_mul_f32 v[102:103], v[102:103], v[42:43]
  v_exp_f32 v100, v100
  v_exp_f32 v101, v101
  v_exp_f32 v102, v102
  v_exp_f32 v103, v103
  v_pk_add_f32 v[100:101], v[100:101], v[108:109]
  v_pk_add_f32 v[102:103], v[102:103], v[108:109]
  v_rcp_f32 v100, v100
  v_rcp_f32 v101, v101
  v_rcp_f32 v102, v102
  v_rcp_f32 v103, v103
  v_pk_mul_f32 v[40:41], v[40:41], v[100:101]
  v_pk_mul_f32 v[42:43], v[42:43], v[102:103]
  v_cvt_pk_bf16_f32 v146, v40, v41
  v_cvt_pk_bf16_f32 v147, v42, v43
  s_nop 0
  v_permlane16_swap_b32 v144, v146
  v_permlane16_swap_b32 v145, v147
  buffer_store_dwordx4 v[144:147], v8, s[52:55], s10 offen offset:0
  v_pk_mul_f32 v[36:37], v[36:37], v[92:93]
  v_pk_fma_f32 v[36:37], v[120:121], v[94:95], v[36:37]
  v_pk_mul_f32 v[38:39], v[38:39], v[92:93]
  v_pk_fma_f32 v[38:39], v[122:123], v[94:95], v[38:39]
  v_pk_mul_f32 v[100:101], v[36:37], v[36:37]
  v_pk_mul_f32 v[102:103], v[38:39], v[38:39]
  v_pk_fma_f32 v[100:101], v[100:101], v[104:105], v[106:107]
  v_pk_fma_f32 v[102:103], v[102:103], v[104:105], v[106:107]
  v_pk_mul_f32 v[100:101], v[100:101], v[36:37]
  v_pk_mul_f32 v[102:103], v[102:103], v[38:39]
  v_exp_f32 v100, v100
  v_exp_f32 v101, v101
  v_exp_f32 v102, v102
  v_exp_f32 v103, v103
  v_pk_add_f32 v[100:101], v[100:101], v[108:109]
  v_pk_add_f32 v[102:103], v[102:103], v[108:109]
  v_rcp_f32 v100, v100
  v_rcp_f32 v101, v101
  v_rcp_f32 v102, v102
  v_rcp_f32 v103, v103
  v_pk_mul_f32 v[36:37], v[36:37], v[100:101]
  v_pk_mul_f32 v[38:39], v[38:39], v[102:103]
  v_cvt_pk_bf16_f32 v148, v36, v37
  v_cvt_pk_bf16_f32 v149, v38, v39
  v_pk_mul_f32 v[44:45], v[44:45], v[92:93]
  v_pk_fma_f32 v[44:45], v[124:125], v[94:95], v[44:45]
  v_pk_mul_f32 v[46:47], v[46:47], v[92:93]
  v_pk_fma_f32 v[46:47], v[126:127], v[94:95], v[46:47]
  v_pk_mul_f32 v[100:101], v[44:45], v[44:45]
  v_pk_mul_f32 v[102:103], v[46:47], v[46:47]
  v_pk_fma_f32 v[100:101], v[100:101], v[104:105], v[106:107]
  v_pk_fma_f32 v[102:103], v[102:103], v[104:105], v[106:107]
  v_pk_mul_f32 v[100:101], v[100:101], v[44:45]
  v_pk_mul_f32 v[102:103], v[102:103], v[46:47]
  v_exp_f32 v100, v100
  v_exp_f32 v101, v101
  v_exp_f32 v102, v102
  v_exp_f32 v103, v103
  v_pk_add_f32 v[100:101], v[100:101], v[108:109]
  v_pk_add_f32 v[102:103], v[102:103], v[108:109]
  v_rcp_f32 v100, v100
  v_rcp_f32 v101, v101
  v_rcp_f32 v102, v102
  v_rcp_f32 v103, v103
  v_pk_mul_f32 v[44:45], v[44:45], v[100:101]
  v_pk_mul_f32 v[46:47], v[46:47], v[102:103]
  v_cvt_pk_bf16_f32 v150, v44, v45
  v_cvt_pk_bf16_f32 v151, v46, v47
  s_nop 0
  v_permlane16_swap_b32 v148, v150
  v_permlane16_swap_b32 v149, v151
  buffer_store_dwordx4 v[148:151], v8, s[52:55], s10 offen offset:2048
  v_pk_mul_f32 v[48:49], v[48:49], v[88:89]
  v_pk_fma_f32 v[48:49], v[128:129], v[90:91], v[48:49]
  v_pk_mul_f32 v[50:51], v[50:51], v[88:89]
  v_pk_fma_f32 v[50:51], v[130:131], v[90:91], v[50:51]
  v_pk_mul_f32 v[100:101], v[48:49], v[48:49]
  v_pk_mul_f32 v[102:103], v[50:51], v[50:51]
  v_pk_fma_f32 v[100:101], v[100:101], v[104:105], v[106:107]
  v_pk_fma_f32 v[102:103], v[102:103], v[104:105], v[106:107]
  v_pk_mul_f32 v[100:101], v[100:101], v[48:49]
  v_pk_mul_f32 v[102:103], v[102:103], v[50:51]
  v_exp_f32 v100, v100
  v_exp_f32 v101, v101
  v_exp_f32 v102, v102
  v_exp_f32 v103, v103
  v_pk_add_f32 v[100:101], v[100:101], v[108:109]
  v_pk_add_f32 v[102:103], v[102:103], v[108:109]
  v_rcp_f32 v100, v100
  v_rcp_f32 v101, v101
  v_rcp_f32 v102, v102
  v_rcp_f32 v103, v103
  v_pk_mul_f32 v[48:49], v[48:49], v[100:101]
  v_pk_mul_f32 v[50:51], v[50:51], v[102:103]
  v_cvt_pk_bf16_f32 v152, v48, v49
  v_cvt_pk_bf16_f32 v153, v50, v51
  v_pk_mul_f32 v[56:57], v[56:57], v[88:89]
  v_pk_fma_f32 v[56:57], v[132:133], v[90:91], v[56:57]
  v_pk_mul_f32 v[58:59], v[58:59], v[88:89]
  v_pk_fma_f32 v[58:59], v[134:135], v[90:91], v[58:59]
  v_pk_mul_f32 v[100:101], v[56:57], v[56:57]
  v_pk_mul_f32 v[102:103], v[58:59], v[58:59]
  v_pk_fma_f32 v[100:101], v[100:101], v[104:105], v[106:107]
  v_pk_fma_f32 v[102:103], v[102:103], v[104:105], v[106:107]
  v_pk_mul_f32 v[100:101], v[100:101], v[56:57]
  v_pk_mul_f32 v[102:103], v[102:103], v[58:59]
  v_exp_f32 v100, v100
  v_exp_f32 v101, v101
  v_exp_f32 v102, v102
  v_exp_f32 v103, v103
  v_pk_add_f32 v[100:101], v[100:101], v[108:109]
  v_pk_add_f32 v[102:103], v[102:103], v[108:109]
  v_rcp_f32 v100, v100
  v_rcp_f32 v101, v101
  v_rcp_f32 v102, v102
  v_rcp_f32 v103, v103
  v_pk_mul_f32 v[56:57], v[56:57], v[100:101]
  v_pk_mul_f32 v[58:59], v[58:59], v[102:103]
  v_cvt_pk_bf16_f32 v154, v56, v57
  v_cvt_pk_bf16_f32 v155, v58, v59
  s_nop 0
  v_permlane16_swap_b32 v152, v154
  v_permlane16_swap_b32 v153, v155
  buffer_store_dwordx4 v[152:155], v9, s[52:55], s10 offen offset:0
  v_pk_mul_f32 v[52:53], v[52:53], v[92:93]
  v_pk_fma_f32 v[52:53], v[128:129], v[94:95], v[52:53]
  v_pk_mul_f32 v[54:55], v[54:55], v[92:93]
  v_pk_fma_f32 v[54:55], v[130:131], v[94:95], v[54:55]
  v_pk_mul_f32 v[100:101], v[52:53], v[52:53]
  v_pk_mul_f32 v[102:103], v[54:55], v[54:55]
  v_pk_fma_f32 v[100:101], v[100:101], v[104:105], v[106:107]
  v_pk_fma_f32 v[102:103], v[102:103], v[104:105], v[106:107]
  v_pk_mul_f32 v[100:101], v[100:101], v[52:53]
  v_pk_mul_f32 v[102:103], v[102:103], v[54:55]
  v_exp_f32 v100, v100
  v_exp_f32 v101, v101
  v_exp_f32 v102, v102
  v_exp_f32 v103, v103
  v_pk_add_f32 v[100:101], v[100:101], v[108:109]
  v_pk_add_f32 v[102:103], v[102:103], v[108:109]
  v_rcp_f32 v100, v100
  v_rcp_f32 v101, v101
  v_rcp_f32 v102, v102
  v_rcp_f32 v103, v103
  v_pk_mul_f32 v[52:53], v[52:53], v[100:101]
  v_pk_mul_f32 v[54:55], v[54:55], v[102:103]
  v_cvt_pk_bf16_f32 v156, v52, v53
  v_cvt_pk_bf16_f32 v157, v54, v55
  v_pk_mul_f32 v[60:61], v[60:61], v[92:93]
  v_pk_fma_f32 v[60:61], v[132:133], v[94:95], v[60:61]
  v_pk_mul_f32 v[62:63], v[62:63], v[92:93]
  v_pk_fma_f32 v[62:63], v[134:135], v[94:95], v[62:63]
  v_pk_mul_f32 v[100:101], v[60:61], v[60:61]
  v_pk_mul_f32 v[102:103], v[62:63], v[62:63]
  v_pk_fma_f32 v[100:101], v[100:101], v[104:105], v[106:107]
  v_pk_fma_f32 v[102:103], v[102:103], v[104:105], v[106:107]
  v_pk_mul_f32 v[100:101], v[100:101], v[60:61]
  v_pk_mul_f32 v[102:103], v[102:103], v[62:63]
  v_exp_f32 v100, v100
  v_exp_f32 v101, v101
  v_exp_f32 v102, v102
  v_exp_f32 v103, v103
  v_pk_add_f32 v[100:101], v[100:101], v[108:109]
  v_pk_add_f32 v[102:103], v[102:103], v[108:109]
  v_rcp_f32 v100, v100
  v_rcp_f32 v101, v101
  v_rcp_f32 v102, v102
  v_rcp_f32 v103, v103
  v_pk_mul_f32 v[60:61], v[60:61], v[100:101]
  v_pk_mul_f32 v[62:63], v[62:63], v[102:103]
  v_cvt_pk_bf16_f32 v158, v60, v61
  v_cvt_pk_bf16_f32 v159, v62, v63
  s_nop 0
  v_permlane16_swap_b32 v156, v158
  v_permlane16_swap_b32 v157, v159
  buffer_store_dwordx4 v[156:159], v9, s[52:55], s10 offen offset:2048
  s_mul_i32 s9, s4, 160
  v_lshl_add_u32 v6, v235, 3, s9
  global_load_dwordx2 v[56:57], v6, s[32:33] offset:0
  global_load_dwordx2 v[58:59], v6, s[32:33] offset:32
  global_load_dwordx2 v[60:61], v6, s[32:33] offset:64
  global_load_dwordx2 v[62:63], v6, s[32:33] offset:96
  global_load_dwordx2 v[64:65], v6, s[32:33] offset:128
  v_and_b32 v2, 6, v234
  v_xor_b32 v2, v2, v235
  v_lshlrev_b32 v2, 4, v2
  v_lshl_add_u32 v2, v234, 7, v2
  v_add_u32 v239, 81920, v2
  v_lshrrev_b32 v2, 1, v235
  v_lshlrev_b32 v2, 4, v2
  v_and_b32 v3, 1, v235
  v_lshl_add_u32 v2, v3, 2, v2
  v_lshrrev_b32 v3, 2, v234
  v_add_u32 v2, v2, v3
  v_bfe_u32 v3, v0, 1, 1
  s_lshl_b32 s8, s51, 1
  v_add_u32 v3, s8, v3
  v_and_b32 v4, 6, v2
  v_xor_b32 v3, v3, v4
  v_lshlrev_b32 v3, 4, v3
  v_lshl_add_u32 v3, v2, 7, v3
  v_and_b32 v4, 1, v0
  v_lshl_add_u32 v241, v4, 3, v3
  v_mov_b32 v16, 0
  v_mov_b32 v17, 0
  v_mov_b32 v18, 0
  v_mov_b32 v19, 0
  v_mov_b32 v20, 0
  v_mov_b32 v21, 0
  v_mov_b32 v22, 0
  v_mov_b32 v23, 0
  v_mov_b32 v24, 0
  v_mov_b32 v25, 0
  v_mov_b32 v26, 0
  v_mov_b32 v27, 0
  v_mov_b32 v28, 0
  v_mov_b32 v29, 0
  v_mov_b32 v30, 0
  v_mov_b32 v31, 0
  v_mov_b32 v32, 0
  v_mov_b32 v33, 0
  v_mov_b32 v34, 0
  v_mov_b32 v35, 0
  v_mov_b32 v132, 0
  v_mov_b32 v133, 0
  v_mov_b32 v134, 0
  v_mov_b32 v135, 0
  v_mov_b32 v136, 0
  v_mov_b32 v137, 0
  v_mov_b32 v138, 0
  v_mov_b32 v139, 0
  v_mov_b32 v140, 0
  v_mov_b32 v141, 0
  v_mov_b32 v142, 0
  v_mov_b32 v143, 0
  v_mov_b32 v144, 0
  v_mov_b32 v145, 0
  v_mov_b32 v146, 0
  v_mov_b32 v147, 0
  v_mov_b32 v148, 0
  v_mov_b32 v149, 0
  v_mov_b32 v150, 0
  v_mov_b32 v151, 0
  v_mov_b32 v152, 0
  v_mov_b32 v153, 0
  v_mov_b32 v154, 0
  v_mov_b32 v155, 0
  s_mov_b32 s65, 0
  s_mul_i32 s8, s64, 20480
  v_add_u32 v254, s8, v239
  v_xor_b32 v15, 64, v254
  v_add_u32 v255, s65, v241
  s_mov_b32 s101, 3
  s_call_b64 s[30:31], L_t4sub
  s_waitcnt vmcnt(0)
  s_cmp_eq_u32 s100, 1
  s_cbranch_scc1 L_pubf4
  s_waitcnt vmcnt(0)
  buffer_wbl2 sc1
  s_waitcnt vmcnt(0)
L_pubf4:
  s_lshl_b32 s8, s5, 3
  s_add_u32 s8, s8, s4
  s_lshl_b32 s8, s8, 7
  s_lshl_b32 s9, s51, 2
  s_add_u32 s8, s8, s9
  s_add_u32 s8, s8, 163840
  v_mov_b32 v2, s7
  v_mov_b32 v3, 0
  s_mov_b64 exec, 1
  s_cmp_eq_u32 s100, 1
  s_cbranch_scc1 L_pubg4
  buffer_store_dword v2, v3, s[52:55], s8 offen sc1
  s_branch L_pubh4
L_pubg4:
  buffer_store_dword v2, v3, s[52:55], s8 offen
L_pubh4:
  s_mov_b64 exec, -1
  s_mov_b32 s101, 7
  s_call_b64 s[30:31], L_t4sub
  v_mfma_f32_16x16x32_bf16 v[16:19], v[136:139], v[132:135], v[16:19]
  v_mfma_f32_16x16x32_bf16 v[20:23], v[140:143], v[132:135], v[20:23]
  v_mfma_f32_16x16x32_bf16 v[24:27], v[144:147], v[132:135], v[24:27]
  v_mfma_f32_16x16x32_bf16 v[28:31], v[148:151], v[132:135], v[28:31]
  v_mfma_f32_16x16x32_bf16 v[32:35], v[152:155], v[132:135], v[32:35]
  v_mov_b32 v76, 0
  v_mov_b32 v77, 0
  v_mov_b32 v78, 0
  v_mov_b32 v79, 0
  v_mov_b32 v80, 0
  v_mov_b32 v81, 0
  v_mov_b32 v82, 0
  v_mov_b32 v83, 0
  v_mov_b32 v84, 0
  v_mov_b32 v85, 0
  v_mov_b32 v86, 0
  v_mov_b32 v87, 0
  v_mov_b32 v88, 0
  v_mov_b32 v89, 0
  v_mov_b32 v90, 0
  v_mov_b32 v91, 0
  v_mov_b32 v92, 0
  v_mov_b32 v93, 0
  v_mov_b32 v94, 0
  v_mov_b32 v95, 0
  v_mov_b32 v132, 0
  v_mov_b32 v133, 0
  v_mov_b32 v134, 0
  v_mov_b32 v135, 0
  v_mov_b32 v136, 0
  v_mov_b32 v137, 0
  v_mov_b32 v138, 0
  v_mov_b32 v139, 0
  v_mov_b32 v140, 0
  v_mov_b32 v141, 0
  v_mov_b32 v142, 0
  v_mov_b32 v143, 0
  v_mov_b32 v144, 0
  v_mov_b32 v145, 0
  v_mov_b32 v146, 0
  v_mov_b32 v147, 0
  v_mov_b32 v148, 0
  v_mov_b32 v149, 0
  v_mov_b32 v150, 0
  v_mov_b32 v151, 0
  v_mov_b32 v152, 0
  v_mov_b32 v153, 0
  v_mov_b32 v154, 0
  v_mov_b32 v155, 0
  s_mul_i32 s8, s64, 20480
  v_add_u32 v254, s8, v236
  v_add_u32 v255, s65, v237
  v_add_u32 v15, s65, v238
  s_mov_b32 s101, 12
  s_call_b64 s[30:31], L_gemm80
  v_mfma_f32_16x16x32_bf16 v[76:79], v[136:139], v[132:135], v[76:79]
  v_mfma_f32_16x16x32_bf16 v[80:83], v[140:143], v[132:135], v[80:83]
  v_mfma_f32_16x16x32_bf16 v[84:87], v[144:147], v[132:135], v[84:87]
  v_mfma_f32_16x16x32_bf16 v[88:91], v[148:151], v[132:135], v[88:91]
  v_mfma_f32_16x16x32_bf16 v[92:95], v[152:155], v[132:135], v[92:95]
  s_waitcnt vmcnt(0)
  v_mul_f32 v100, v245, v246
  v_sub_f32 v100, 0, v100
  v_mov_b32 v101, v100
  v_mov_b32 v102, v246
  v_mov_b32 v103, v246
  v_mov_b32 v104, 0xbfb8aa3b
  v_mov_b32 v105, 0xbfb8aa3b
  v_mov_b32 v106, 1.0
  v_mov_b32 v107, 1.0
  s_lshl_b32 s8, s51, 4
  s_add_u32 s8, s8, s6
  v_add_u32 v2, s8, v234
  v_mul_u32_u24 v2, 2560, v2
  s_mul_i32 s9, s4, 320
  v_lshl_add_u32 v3, v235, 4, s9
  v_add_u32 v2, v2, v3
  v_lshlrev_b32 v108, 16, v174
  v_and_b32 v109, s66, v174
  v_lshlrev_b32 v116, 16, v164
  v_and_b32 v117, s66, v164
  v_lshlrev_b32 v112, 16, v56
  v_and_b32 v113, s66, v56
  v_lshlrev_b32 v110, 16, v175
  v_and_b32 v111, s66, v175
  v_lshlrev_b32 v118, 16, v165
  v_and_b32 v119, s66, v165
  v_lshlrev_b32 v114, 16, v57
  v_and_b32 v115, s66, v57
  v_pk_add_f32 v[108:109], v[108:109], v[76:77]
  v_pk_add_f32 v[110:111], v[110:111], v[78:79]
  v_pk_mul_f32 v[120:121], v[108:109], v[104:105]
  v_pk_mul_f32 v[122:123], v[110:111], v[104:105]
  v_exp_f32 v120, v120
  v_exp_f32 v121, v121
  v_exp_f32 v122, v122
  v_exp_f32 v123, v123
  v_pk_add_f32 v[120:121], v[120:121], v[106:107]
  v_pk_add_f32 v[122:123], v[122:123], v[106:107]
  v_rcp_f32 v120, v120
  v_rcp_f32 v121, v121
  v_rcp_f32 v122, v122
  v_rcp_f32 v123, v123
  v_pk_mul_f32 v[108:109], v[108:109], v[120:121]
  v_pk_mul_f32 v[110:111], v[110:111], v[122:123]
  v_pk_fma_f32 v[120:121], v[116:117], v[102:103], v[100:101]
  v_pk_fma_f32 v[122:123], v[118:119], v[102:103], v[100:101]
  v_pk_fma_f32 v[120:121], v[120:121], v[112:113], v[16:17]
  v_pk_fma_f32 v[122:123], v[122:123], v[114:115], v[18:19]
  v_pk_fma_f32 v[120:121], v[120:121], v[108:109], v[116:117]
  v_pk_fma_f32 v[122:123], v[122:123], v[110:111], v[118:119]
  buffer_store_dwordx4 v[120:123], v2, s[60:63], 0 offen offset:0
  v_lshlrev_b32 v108, 16, v176
  v_and_b32 v109, s66, v176
  v_lshlrev_b32 v116, 16, v166
  v_and_b32 v117, s66, v166
  v_lshlrev_b32 v112, 16, v58
  v_and_b32 v113, s66, v58
  v_lshlrev_b32 v110, 16, v177
  v_and_b32 v111, s66, v177
  v_lshlrev_b32 v118, 16, v167
  v_and_b32 v119, s66, v167
  v_lshlrev_b32 v114, 16, v59
  v_and_b32 v115, s66, v59
  v_pk_add_f32 v[108:109], v[108:109], v[80:81]
  v_pk_add_f32 v[110:111], v[110:111], v[82:83]
  v_pk_mul_f32 v[124:125], v[108:109], v[104:105]
  v_pk_mul_f32 v[126:127], v[110:111], v[104:105]
  v_exp_f32 v124, v124
  v_exp_f32 v125, v125
  v_exp_f32 v126, v126
  v_exp_f32 v127, v127
  v_pk_add_f32 v[124:125], v[124:125], v[106:107]
  v_pk_add_f32 v[126:127], v[126:127], v[106:107]
  v_rcp_f32 v124, v124
  v_rcp_f32 v125, v125
  v_rcp_f32 v126, v126
  v_rcp_f32 v127, v127
  v_pk_mul_f32 v[108:109], v[108:109], v[124:125]
  v_pk_mul_f32 v[110:111], v[110:111], v[126:127]
  v_pk_fma_f32 v[124:125], v[116:117], v[102:103], v[100:101]
  v_pk_fma_f32 v[126:127], v[118:119], v[102:103], v[100:101]
  v_pk_fma_f32 v[124:125], v[124:125], v[112:113], v[20:21]
  v_pk_fma_f32 v[126:127], v[126:127], v[114:115], v[22:23]
  v_pk_fma_f32 v[124:125], v[124:125], v[108:109], v[116:117]
  v_pk_fma_f32 v[126:127], v[126:127], v[110:111], v[118:119]
  buffer_store_dwordx4 v[124:127], v2, s[60:63], 0 offen offset:64
  v_lshlrev_b32 v108, 16, v178
  v_and_b32 v109, s66, v178
  v_lshlrev_b32 v116, 16, v168
  v_and_b32 v117, s66, v168
  v_lshlrev_b32 v112, 16, v60
  v_and_b32 v113, s66, v60
  v_lshlrev_b32 v110, 16, v179
  v_and_b32 v111, s66, v179
  v_lshlrev_b32 v118, 16, v169
  v_and_b32 v119, s66, v169
  v_lshlrev_b32 v114, 16, v61
  v_and_b32 v115, s66, v61
  v_pk_add_f32 v[108:109], v[108:109], v[84:85]
  v_pk_add_f32 v[110:111], v[110:111], v[86:87]
  v_pk_mul_f32 v[128:129], v[108:109], v[104:105]
  v_pk_mul_f32 v[130:131], v[110:111], v[104:105]
  v_exp_f32 v128, v128
  v_exp_f32 v129, v129
  v_exp_f32 v130, v130
  v_exp_f32 v131, v131
  v_pk_add_f32 v[128:129], v[128:129], v[106:107]
  v_pk_add_f32 v[130:131], v[130:131], v[106:107]
  v_rcp_f32 v128, v128
  v_rcp_f32 v129, v129
  v_rcp_f32 v130, v130
  v_rcp_f32 v131, v131
  v_pk_mul_f32 v[108:109], v[108:109], v[128:129]
  v_pk_mul_f32 v[110:111], v[110:111], v[130:131]
  v_pk_fma_f32 v[128:129], v[116:117], v[102:103], v[100:101]
  v_pk_fma_f32 v[130:131], v[118:119], v[102:103], v[100:101]
  v_pk_fma_f32 v[128:129], v[128:129], v[112:113], v[24:25]
  v_pk_fma_f32 v[130:131], v[130:131], v[114:115], v[26:27]
  v_pk_fma_f32 v[128:129], v[128:129], v[108:109], v[116:117]
  v_pk_fma_f32 v[130:131], v[130:131], v[110:111], v[118:119]
  buffer_store_dwordx4 v[128:131], v2, s[60:63], 0 offen offset:128
  v_lshlrev_b32 v108, 16, v180
  v_and_b32 v109, s66, v180
  v_lshlrev_b32 v116, 16, v170
  v_and_b32 v117, s66, v170
  v_lshlrev_b32 v112, 16, v62
  v_and_b32 v113, s66, v62
  v_lshlrev_b32 v110, 16, v181
  v_and_b32 v111, s66, v181
  v_lshlrev_b32 v118, 16, v171
  v_and_b32 v119, s66, v171
  v_lshlrev_b32 v114, 16, v63
  v_and_b32 v115, s66, v63
  v_pk_add_f32 v[108:109], v[108:109], v[88:89]
  v_pk_add_f32 v[110:111], v[110:111], v[90:91]
  v_pk_mul_f32 v[132:133], v[108:109], v[104:105]
  v_pk_mul_f32 v[134:135], v[110:111], v[104:105]
  v_exp_f32 v132, v132
  v_exp_f32 v133, v133
  v_exp_f32 v134, v134
  v_exp_f32 v135, v135
  v_pk_add_f32 v[132:133], v[132:133], v[106:107]
  v_pk_add_f32 v[134:135], v[134:135], v[106:107]
  v_rcp_f32 v132, v132
  v_rcp_f32 v133, v133
  v_rcp_f32 v134, v134
  v_rcp_f32 v135, v135
  v_pk_mul_f32 v[108:109], v[108:109], v[132:133]
  v_pk_mul_f32 v[110:111], v[110:111], v[134:135]
  v_pk_fma_f32 v[132:133], v[116:117], v[102:103], v[100:101]
  v_pk_fma_f32 v[134:135], v[118:119], v[102:103], v[100:101]
  v_pk_fma_f32 v[132:133], v[132:133], v[112:113], v[28:29]
  v_pk_fma_f32 v[134:135], v[134:135], v[114:115], v[30:31]
  v_pk_fma_f32 v[132:133], v[132:133], v[108:109], v[116:117]
  v_pk_fma_f32 v[134:135], v[134:135], v[110:111], v[118:119]
  buffer_store_dwordx4 v[132:135], v2, s[60:63], 0 offen offset:192
  v_lshlrev_b32 v108, 16, v182
  v_and_b32 v109, s66, v182
  v_lshlrev_b32 v116, 16, v172
  v_and_b32 v117, s66, v172
  v_lshlrev_b32 v112, 16, v64
  v_and_b32 v113, s66, v64
  v_lshlrev_b32 v110, 16, v183
  v_and_b32 v111, s66, v183
  v_lshlrev_b32 v118, 16, v173
  v_and_b32 v119, s66, v173
  v_lshlrev_b32 v114, 16, v65
  v_and_b32 v115, s66, v65
  v_pk_add_f32 v[108:109], v[108:109], v[92:93]
  v_pk_add_f32 v[110:111], v[110:111], v[94:95]
  v_pk_mul_f32 v[136:137], v[108:109], v[104:105]
  v_pk_mul_f32 v[138:139], v[110:111], v[104:105]
  v_exp_f32 v136, v136
  v_exp_f32 v137, v137
  v_exp_f32 v138, v138
  v_exp_f32 v139, v139
  v_pk_add_f32 v[136:137], v[136:137], v[106:107]
  v_pk_add_f32 v[138:139], v[138:139], v[106:107]
  v_rcp_f32 v136, v136
  v_rcp_f32 v137, v137
  v_rcp_f32 v138, v138
  v_rcp_f32 v139, v139
  v_pk_mul_f32 v[108:109], v[108:109], v[136:137]
  v_pk_mul_f32 v[110:111], v[110:111], v[138:139]
  v_pk_fma_f32 v[136:137], v[116:117], v[102:103], v[100:101]
  v_pk_fma_f32 v[138:139], v[118:119], v[102:103], v[100:101]
  v_pk_fma_f32 v[136:137], v[136:137], v[112:113], v[32:33]
  v_pk_fma_f32 v[138:139], v[138:139], v[114:115], v[34:35]
  v_pk_fma_f32 v[136:137], v[136:137], v[108:109], v[116:117]
  v_pk_fma_f32 v[138:139], v[138:139], v[110:111], v[118:119]
  buffer_store_dwordx4 v[136:139], v2, s[60:63], 0 offen offset:256
  s_cmp_lg_u32 s2, 0
  s_cbranch_scc1 L_exit
  s_cmp_lg_u32 s51, 0
  s_cbranch_scc1 L_exit
  v_lshlrev_b32 v2, 7, v0
  s_mov_b32 s12, 0
L_epoll:
  s_mov_b32 s9, 196608
  buffer_load_dword v4, v2, s[52:55], s9 offen sc1
  s_add_u32 s9, s9, 8192
  buffer_load_dword v5, v2, s[52:55], s9 offen sc1
  s_add_u32 s9, s9, 8192
  buffer_load_dword v6, v2, s[52:55], s9 offen sc1
  s_add_u32 s9, s9, 8192
  buffer_load_dword v7, v2, s[52:55], s9 offen sc1
  s_add_u32 s12, s12, 1
  s_waitcnt vmcnt(0)
  v_subrev_u32 v4, s7, v4
  v_subrev_u32 v5, s7, v5
  v_subrev_u32 v6, s7, v6
  v_subrev_u32 v7, s7, v7
  v_max_u32 v4, v4, v5
  v_max_u32 v6, v6, v7
  v_max_u32 v4, v4, v6
  v_cmp_lt_u32 vcc, 7, v4
  s_nop 4
  s_cbranch_vccz L_epd
  s_cmp_lt_u32 s12, 0x8000
  s_cbranch_scc1 L_epoll
L_epd:
  v_mov_b32 v2, 0
  v_mov_b32 v3, s7
  s_mov_b64 exec, 1
  buffer_store_dword v3, v2, s[52:55], 0 offen sc1
  s_waitcnt vmcnt(0)
L_exit:
  s_endpgm
L_gemm80:
  s_barrier
  ds_read_b128 v[100:103], v255 offset:0
  ds_read_b64_tr_b16 v[104:105], v254 offset:0
  v_mfma_f32_16x16x32_bf16 v[76:79], v[136:139], v[132:135], v[76:79]
  ds_read_b64_tr_b16 v[106:107], v254 offset:1280
  ds_read_b64_tr_b16 v[108:109], v254 offset:32
  v_mfma_f32_16x16x32_bf16 v[80:83], v[140:143], v[132:135], v[80:83]
  ds_read_b64_tr_b16 v[110:111], v254 offset:1312
  ds_read_b64_tr_b16 v[112:113], v254 offset:64
  v_mfma_f32_16x16x32_bf16 v[84:87], v[144:147], v[132:135], v[84:87]
  ds_read_b64_tr_b16 v[114:115], v254 offset:1344
  ds_read_b64_tr_b16 v[116:117], v254 offset:96
  v_mfma_f32_16x16x32_bf16 v[88:91], v[148:151], v[132:135], v[88:91]
  ds_read_b64_tr_b16 v[118:119], v254 offset:1376
  ds_read_b64_tr_b16 v[120:121], v254 offset:128
  v_mfma_f32_16x16x32_bf16 v[92:95], v[152:155], v[132:135], v[92:95]
  ds_read_b64_tr_b16 v[122:123], v254 offset:1408
  ds_read_b128 v[132:135], v15 offset:0
  s_waitcnt lgkmcnt(7)
  v_mfma_f32_16x16x32_bf16 v[76:79], v[104:107], v[100:103], v[76:79]
  ds_read_b64_tr_b16 v[136:137], v254 offset:5120
  ds_read_b64_tr_b16 v[138:139], v254 offset:6400
  v_mfma_f32_16x16x32_bf16 v[80:83], v[108:111], v[100:103], v[80:83]
  ds_read_b64_tr_b16 v[140:141], v254 offset:5152
  ds_read_b64_tr_b16 v[142:143], v254 offset:6432
  s_waitcnt lgkmcnt(7)
  v_mfma_f32_16x16x32_bf16 v[84:87], v[112:115], v[100:103], v[84:87]
  ds_read_b64_tr_b16 v[144:145], v254 offset:5184
  ds_read_b64_tr_b16 v[146:147], v254 offset:6464
  v_mfma_f32_16x16x32_bf16 v[88:91], v[116:119], v[100:103], v[88:91]
  ds_read_b64_tr_b16 v[148:149], v254 offset:5216
  ds_read_b64_tr_b16 v[150:151], v254 offset:6496
  s_waitcnt lgkmcnt(6)
  v_mfma_f32_16x16x32_bf16 v[92:95], v[120:123], v[100:103], v[92:95]
  ds_read_b64_tr_b16 v[152:153], v254 offset:5248
  ds_read_b64_tr_b16 v[154:155], v254 offset:6528
  v_mfma_f32_16x16x32_bf16 v[76:79], v[136:139], v[132:135], v[76:79]
  ds_read_b128 v[100:103], v255 offset:8192
  ds_read_b64_tr_b16 v[104:105], v254 offset:10240
  s_waitcnt lgkmcnt(6)
  v_mfma_f32_16x16x32_bf16 v[80:83], v[140:143], v[132:135], v[80:83]
  ds_read_b64_tr_b16 v[106:107], v254 offset:11520
  ds_read_b64_tr_b16 v[108:109], v254 offset:10272
  v_mfma_f32_16x16x32_bf16 v[84:87], v[144:147], v[132:135], v[84:87]
  ds_read_b64_tr_b16 v[110:111], v254 offset:11552
  ds_read_b64_tr_b16 v[112:113], v254 offset:10304
  s_waitcnt lgkmcnt(6)
  v_mfma_f32_16x16x32_bf16 v[88:91], v[148:151], v[132:135], v[88:91]
  ds_read_b64_tr_b16 v[114:115], v254 offset:11584
  ds_read_b64_tr_b16 v[116:117], v254 offset:10336
  v_mfma_f32_16x16x32_bf16 v[92:95], v[152:155], v[132:135], v[92:95]
  ds_read_b64_tr_b16 v[118:119], v254 offset:11616
  ds_read_b64_tr_b16 v[120:121], v254 offset:10368
  s_waitcnt lgkmcnt(5)
  v_mfma_f32_16x16x32_bf16 v[76:79], v[104:107], v[100:103], v[76:79]
  ds_read_b64_tr_b16 v[122:123], v254 offset:11648
  ds_read_b128 v[132:135], v15 offset:8192
  v_mfma_f32_16x16x32_bf16 v[80:83], v[108:111], v[100:103], v[80:83]
  ds_read_b64_tr_b16 v[136:137], v254 offset:15360
  ds_read_b64_tr_b16 v[138:139], v254 offset:16640
  s_waitcnt lgkmcnt(5)
  v_mfma_f32_16x16x32_bf16 v[84:87], v[112:115], v[100:103], v[84:87]
  ds_read_b64_tr_b16 v[140:141], v254 offset:15392
  ds_read_b64_tr_b16 v[142:143], v254 offset:16672
  v_mfma_f32_16x16x32_bf16 v[88:91], v[116:119], v[100:103], v[88:91]
  ds_read_b64_tr_b16 v[144:145], v254 offset:15424
  ds_read_b64_tr_b16 v[146:147], v254 offset:16704
  s_waitcnt lgkmcnt(7)
  v_mfma_f32_16x16x32_bf16 v[92:95], v[120:123], v[100:103], v[92:95]
  ds_read_b64_tr_b16 v[148:149], v254 offset:15456
  ds_read_b64_tr_b16 v[150:151], v254 offset:16736
  ds_read_b64_tr_b16 v[152:153], v254 offset:15488
  ds_read_b64_tr_b16 v[154:155], v254 offset:16768
  s_add_u32 s64, s64, 1
  s_cmp_eq_u32 s64, 3
  s_cselect_b32 s64, 0, s64
  s_add_u32 s65, s65, 16384
  s_cmp_eq_u32 s65, 81920
  s_cselect_b32 s65, 0, s65
  s_mul_i32 s8, s64, 20480
  v_add_u32 v254, s8, v236
  v_add_u32 v255, s65, v237
  v_add_u32 v15, s65, v238
  s_waitcnt lgkmcnt(0)
  s_sub_u32 s101, s101, 1
  s_cmp_lg_u32 s101, 0
  s_cbranch_scc1 L_gemm80
  s_setpc_b64 s[30:31]
L_tileaddr:
  v_add_u32 v3, s11, v0
  v_mul_u32_u24 v4, 6554, v3
  v_lshrrev_b32 v4, 16, v4
  v_mul_u32_u24 v5, 10, v4
  v_sub_u32 v5, v3, v5
  v_add_u32 v4, s69, v4
  s_mul_i32 s10, s4, 10
  v_add_u32 v5, s10, v5
  v_lshrrev_b32 v6, 6, v4
  v_mul_u32_u24 v6, 81920, v6
  v_and_b32 v7, 63, v4
  v_lshl_add_u32 v6, v7, 7, v6
  v_and_b32 v8, 2, v7
  v_lshrrev_b32 v7, 1, v7
  v_and_b32 v7, 4, v7
  v_or_b32 v7, v7, v8
  v_lshrrev_b32 v8, 3, v5
  v_lshl_add_u32 v6, v8, 13, v6
  v_and_b32 v5, 7, v5
  v_xor_b32 v5, v5, v7
  v_lshl_add_u32 v9, v5, 4, v6
  v_cmp_gt_u32 vcc, 2048, v4
  v_cmp_gt_u32 s[96:97], s71, v3
  s_nop 3
  s_and_b64 vcc, vcc, s[96:97]
  v_mov_b32 v5, 2147483632
  v_cndmask_b32 v9, v5, v9, vcc
  s_setpc_b64 s[30:31]
L_t4sub:
  s_barrier
  ds_read_b64_tr_b16 v[100:101], v255 offset:0
  ds_read_b64_tr_b16 v[102:103], v255 offset:1024
  v_mfma_f32_16x16x32_bf16 v[16:19], v[136:139], v[132:135], v[16:19]
  ds_read_b128 v[104:107], v254 offset:0
  ds_read_b128 v[108:111], v254 offset:2048
  v_mfma_f32_16x16x32_bf16 v[20:23], v[140:143], v[132:135], v[20:23]
  ds_read_b128 v[112:115], v254 offset:4096
  ds_read_b128 v[116:119], v254 offset:6144
  v_mfma_f32_16x16x32_bf16 v[24:27], v[144:147], v[132:135], v[24:27]
  ds_read_b128 v[120:123], v254 offset:8192
  v_mfma_f32_16x16x32_bf16 v[28:31], v[148:151], v[132:135], v[28:31]
  v_mfma_f32_16x16x32_bf16 v[32:35], v[152:155], v[132:135], v[32:35]
  ds_read_b64_tr_b16 v[132:133], v255 offset:4096
  ds_read_b64_tr_b16 v[134:135], v255 offset:5120
  s_waitcnt lgkmcnt(5)
  v_mfma_f32_16x16x32_bf16 v[16:19], v[104:107], v[100:103], v[16:19]
  ds_read_b128 v[136:139], v15 offset:0
  ds_read_b128 v[140:143], v15 offset:2048
  v_mfma_f32_16x16x32_bf16 v[20:23], v[108:111], v[100:103], v[20:23]
  ds_read_b128 v[144:147], v15 offset:4096
  ds_read_b128 v[148:151], v15 offset:6144
  s_waitcnt lgkmcnt(7)
  v_mfma_f32_16x16x32_bf16 v[24:27], v[112:115], v[100:103], v[24:27]
  ds_read_b128 v[152:155], v15 offset:8192
  v_mfma_f32_16x16x32_bf16 v[28:31], v[116:119], v[100:103], v[28:31]
  s_waitcnt lgkmcnt(4)
  v_mfma_f32_16x16x32_bf16 v[32:35], v[120:123], v[100:103], v[32:35]
  ds_read_b64_tr_b16 v[100:101], v255 offset:8192
  ds_read_b64_tr_b16 v[102:103], v255 offset:9216
  v_mfma_f32_16x16x32_bf16 v[16:19], v[136:139], v[132:135], v[16:19]
  ds_read_b128 v[104:107], v254 offset:10240
  ds_read_b128 v[108:111], v254 offset:12288
  s_waitcnt lgkmcnt(6)
  v_mfma_f32_16x16x32_bf16 v[20:23], v[140:143], v[132:135], v[20:23]
  ds_read_b128 v[112:115], v254 offset:14336
  ds_read_b128 v[116:119], v254 offset:16384
  v_mfma_f32_16x16x32_bf16 v[24:27], v[144:147], v[132:135], v[24:27]
  ds_read_b128 v[120:123], v254 offset:18432
  s_waitcnt lgkmcnt(7)
  v_mfma_f32_16x16x32_bf16 v[28:31], v[148:151], v[132:135], v[28:31]
  v_mfma_f32_16x16x32_bf16 v[32:35], v[152:155], v[132:135], v[32:35]
  ds_read_b64_tr_b16 v[132:133], v255 offset:12288
  ds_read_b64_tr_b16 v[134:135], v255 offset:13312
  s_waitcnt lgkmcnt(5)
  v_mfma_f32_16x16x32_bf16 v[16:19], v[104:107], v[100:103], v[16:19]
  ds_read_b128 v[136:139], v15 offset:10240
  ds_read_b128 v[140:143], v15 offset:12288
  v_mfma_f32_16x16x32_bf16 v[20:23], v[108:111], v[100:103], v[20:23]
  ds_read_b128 v[144:147], v15 offset:14336
  ds_read_b128 v[148:151], v15 offset:16384
  s_waitcnt lgkmcnt(7)
  v_mfma_f32_16x16x32_bf16 v[24:27], v[112:115], v[100:103], v[24:27]
  ds_read_b128 v[152:155], v15 offset:18432
  v_mfma_f32_16x16x32_bf16 v[28:31], v[116:119], v[100:103], v[28:31]
  s_add_u32 s64, s64, 1
  s_cmp_eq_u32 s64, 3
  s_waitcnt lgkmcnt(7)
  v_mfma_f32_16x16x32_bf16 v[32:35], v[120:123], v[100:103], v[32:35]
  s_cselect_b32 s64, 0, s64
  s_add_u32 s65, s65, 16384
  s_cmp_eq_u32 s65, 81920
  s_cselect_b32 s65, 0, s65
  s_mul_i32 s8, s64, 20480
  v_add_u32 v254, s8, v239
  v_xor_b32 v15, 64, v254
  v_add_u32 v255, s65, v241
  s_waitcnt lgkmcnt(0)
  s_sub_u32 s101, s101, 1
  s_cmp_lg_u32 s101, 0
  s_cbranch_scc1 L_t4sub
  s_setpc_b64 s[30:31]
L_t3sub:
  s_barrier
  ds_read_b128 v[100:103], v239
  v_mfma_f32_16x16x32_bf16 v[16:19], v[140:143], v[132:135], v[16:19]
  ds_read_b128 v[104:107], v239 offset:2048
  v_mfma_f32_16x16x32_bf16 v[20:23], v[140:143], v[136:139], v[20:23]
  ds_read_b64_tr_b16 v[108:109], v248 offset:0
  v_mfma_f32_16x16x32_bf16 v[76:79], v[140:143], v[6:9], v[76:79]
  ds_read_b64_tr_b16 v[110:111], v248 offset:3072
  v_mfma_f32_16x16x32_bf16 v[24:27], v[144:147], v[132:135], v[24:27]
  ds_read_b64_tr_b16 v[112:113], v249 offset:0
  v_mfma_f32_16x16x32_bf16 v[28:31], v[144:147], v[136:139], v[28:31]
  ds_read_b64_tr_b16 v[114:115], v249 offset:3072
  v_mfma_f32_16x16x32_bf16 v[80:83], v[144:147], v[6:9], v[80:83]
  ds_read_b64_tr_b16 v[116:117], v250 offset:0
  v_mfma_f32_16x16x32_bf16 v[32:35], v[148:151], v[132:135], v[32:35]
  ds_read_b64_tr_b16 v[118:119], v250 offset:3072
  v_mfma_f32_16x16x32_bf16 v[36:39], v[148:151], v[136:139], v[36:39]
  ds_read_b64_tr_b16 v[120:121], v251 offset:0
  v_mfma_f32_16x16x32_bf16 v[84:87], v[148:151], v[6:9], v[84:87]
  ds_read_b64_tr_b16 v[122:123], v251 offset:3072
  v_mfma_f32_16x16x32_bf16 v[40:43], v[152:155], v[132:135], v[40:43]
  ds_read_b64_tr_b16 v[124:125], v252 offset:0
  v_mfma_f32_16x16x32_bf16 v[44:47], v[152:155], v[136:139], v[44:47]
  ds_read_b64_tr_b16 v[126:127], v252 offset:3072
  v_mfma_f32_16x16x32_bf16 v[48:51], v[156:159], v[132:135], v[48:51]
  ds_read_b64_tr_b16 v[128:129], v253 offset:0
  v_mfma_f32_16x16x32_bf16 v[52:55], v[156:159], v[136:139], v[52:55]
  ds_read_b64_tr_b16 v[130:131], v253 offset:3072
  v_mfma_f32_16x16x32_bf16 v[56:59], v[160:163], v[132:135], v[56:59]
  v_mfma_f32_16x16x32_bf16 v[60:63], v[160:163], v[136:139], v[60:63]
  ds_read_b128 v[132:135], v240
  s_waitcnt lgkmcnt(11)
  v_mfma_f32_16x16x32_bf16 v[16:19], v[108:111], v[100:103], v[16:19]
  ds_read_b128 v[136:139], v240 offset:2048
  v_mfma_f32_16x16x32_bf16 v[20:23], v[108:111], v[104:107], v[20:23]
  ds_read_b64_tr_b16 v[140:141], v248 offset:12288
  v_mfma_f32_16x16x32_bf16 v[76:79], v[108:111], v[6:9], v[76:79]
  ds_read_b64_tr_b16 v[142:143], v248 offset:15360
  s_waitcnt lgkmcnt(12)
  v_mfma_f32_16x16x32_bf16 v[24:27], v[112:115], v[100:103], v[24:27]
  ds_read_b64_tr_b16 v[144:145], v249 offset:12288
  v_mfma_f32_16x16x32_bf16 v[28:31], v[112:115], v[104:107], v[28:31]
  ds_read_b64_tr_b16 v[146:147], v249 offset:15360
  v_mfma_f32_16x16x32_bf16 v[80:83], v[112:115], v[6:9], v[80:83]
  ds_read_b64_tr_b16 v[148:149], v250 offset:12288
  s_waitcnt lgkmcnt(13)
  v_mfma_f32_16x16x32_bf16 v[32:35], v[116:119], v[100:103], v[32:35]
  ds_read_b64_tr_b16 v[150:151], v250 offset:15360
  v_mfma_f32_16x16x32_bf16 v[36:39], v[116:119], v[104:107], v[36:39]
  v_mfma_f32_16x16x32_bf16 v[84:87], v[116:119], v[6:9], v[84:87]
  ds_read_b64_tr_b16 v[152:153], v251 offset:12288
  s_waitcnt lgkmcnt(13)
  v_mfma_f32_16x16x32_bf16 v[40:43], v[120:123], v[100:103], v[40:43]
  ds_read_b64_tr_b16 v[154:155], v251 offset:15360
  v_mfma_f32_16x16x32_bf16 v[44:47], v[120:123], v[104:107], v[44:47]
  ds_read_b64_tr_b16 v[156:157], v252 offset:12288
  s_waitcnt lgkmcnt(13)
  v_mfma_f32_16x16x32_bf16 v[48:51], v[124:127], v[100:103], v[48:51]
  ds_read_b64_tr_b16 v[158:159], v252 offset:15360
  v_mfma_f32_16x16x32_bf16 v[52:55], v[124:127], v[104:107], v[52:55]
  ds_read_b64_tr_b16 v[160:161], v253 offset:12288
  s_waitcnt lgkmcnt(13)
  v_mfma_f32_16x16x32_bf16 v[56:59], v[128:131], v[100:103], v[56:59]
  ds_read_b64_tr_b16 v[162:163], v253 offset:15360
  v_mfma_f32_16x16x32_bf16 v[60:63], v[128:131], v[104:107], v[60:63]
  s_add_u32 s64, s64, 1
  s_cmp_eq_u32 s64, 3
  s_cselect_b32 s64, 0, s64
  s_cselect_b32 s8, 73728, 0
  s_sub_u32 s8, 24576, s8
  v_add_u32 v239, 8192, v239
  v_add_u32 v240, 8192, v240
  v_add_u32 v248, s8, v248
  v_add_u32 v249, s8, v249
  v_add_u32 v250, s8, v250
  v_add_u32 v251, s8, v251
  v_add_u32 v252, s8, v252
  v_add_u32 v253, s8, v253
  s_waitcnt lgkmcnt(0)
  s_sub_u32 s101, s101, 1
  s_cmp_lg_u32 s101, 0
  s_cbranch_scc1 L_t3sub
  s_setpc_b64 s[30:31]
L_t1bsub:
  s_barrier
  ds_read_b128 v[100:103], v239
  v_mfma_f32_16x16x32_bf16 v[16:19], v[132:135], v[140:143], v[16:19]
  ds_read_b128 v[104:107], v239 offset:512
  v_mfma_f32_16x16x32_bf16 v[20:23], v[136:139], v[140:143], v[20:23]
  ds_read_b128 v[108:111], v241 offset:0
  v_mfma_f32_16x16x32_bf16 v[24:27], v[132:135], v[144:147], v[24:27]
  ds_read_b128 v[112:115], v241 offset:1024
  v_mfma_f32_16x16x32_bf16 v[28:31], v[136:139], v[144:147], v[28:31]
  ds_read_b128 v[116:119], v241 offset:2048
  v_mfma_f32_16x16x32_bf16 v[32:35], v[132:135], v[148:151], v[32:35]
  ds_read_b128 v[120:123], v241 offset:3072
  v_mfma_f32_16x16x32_bf16 v[36:39], v[136:139], v[148:151], v[36:39]
  ds_read_b128 v[124:127], v241 offset:4096
  v_mfma_f32_16x16x32_bf16 v[40:43], v[132:135], v[152:155], v[40:43]
  v_mfma_f32_16x16x32_bf16 v[44:47], v[136:139], v[152:155], v[44:47]
  v_mfma_f32_16x16x32_bf16 v[48:51], v[132:135], v[156:159], v[48:51]
  ds_read_b128 v[132:135], v240
  v_mfma_f32_16x16x32_bf16 v[52:55], v[136:139], v[156:159], v[52:55]
  ds_read_b128 v[136:139], v240 offset:512
  s_waitcnt lgkmcnt(6)
  v_mfma_f32_16x16x32_bf16 v[16:19], v[100:103], v[108:111], v[16:19]
  ds_read_b128 v[140:143], v242 offset:0
  v_mfma_f32_16x16x32_bf16 v[20:23], v[104:107], v[108:111], v[20:23]
  ds_read_b128 v[144:147], v242 offset:1024
  s_waitcnt lgkmcnt(7)
  v_mfma_f32_16x16x32_bf16 v[24:27], v[100:103], v[112:115], v[24:27]
  ds_read_b128 v[148:151], v242 offset:2048
  v_mfma_f32_16x16x32_bf16 v[28:31], v[104:107], v[112:115], v[28:31]
  ds_read_b128 v[152:155], v242 offset:3072
  s_waitcnt lgkmcnt(8)
  v_mfma_f32_16x16x32_bf16 v[32:35], v[100:103], v[116:119], v[32:35]
  ds_read_b128 v[156:159], v242 offset:4096
  v_mfma_f32_16x16x32_bf16 v[36:39], v[104:107], v[116:119], v[36:39]
  s_add_u32 s64, s64, 1
  s_cmp_eq_u32 s64, 3
  s_waitcnt lgkmcnt(8)
  v_mfma_f32_16x16x32_bf16 v[40:43], v[100:103], v[120:123], v[40:43]
  s_cselect_b32 s64, 0, s64
  s_mul_i32 s8, s64, 20480
  v_mfma_f32_16x16x32_bf16 v[44:47], v[104:107], v[120:123], v[44:47]
  v_add_u32 v241, s8, v243
  v_xor_b32 v242, 64, v241
  s_waitcnt lgkmcnt(7)
  v_mfma_f32_16x16x32_bf16 v[48:51], v[100:103], v[124:127], v[48:51]
  v_add_u32 v239, 8192, v239
  v_add_u32 v240, 8192, v240
  v_mfma_f32_16x16x32_bf16 v[52:55], v[104:107], v[124:127], v[52:55]
  s_waitcnt lgkmcnt(0)
  s_sub_u32 s101, s101, 1
  s_cmp_lg_u32 s101, 0
  s_cbranch_scc1 L_t1bsub
  s_setpc_b64 s[30:31]
L_loader:
  s_setprio 0
  s_cmp_lg_u32 s51, 3
  s_cbranch_scc1 L_noxc
  s_getreg_b32 s12, hwreg(HW_REG_XCC_ID, 0, 4)
  s_and_b32 s12, s12, 7
  s_add_u32 s12, s12, s7
  s_lshl_b32 s8, s2, 7
  s_add_u32 s8, s8, 196608
  v_mov_b32 v27, 0
  v_mov_b32 v28, s12
  s_mov_b64 exec, 1
  buffer_store_dword v28, v27, s[52:55], s8 offen sc1
  s_mov_b64 exec, -1
L_noxc:
  s_mul_i32 s8, s24, 20480
  s_add_u32 m0, s8, s34
  s_nop 0
  buffer_load_dwordx4 v11, s[60:63], s22 offen offset:0 lds
  buffer_load_dwordx4 v12, s[60:63], s22 offen offset:1024 lds
  buffer_load_dwordx4 v13, s[60:63], s22 offen offset:2048 lds
  buffer_load_dwordx4 v14, s[60:63], s22 offen offset:3072 lds
  s_add_u32 m0, m0, 4096
  s_nop 0
  buffer_load_dwordx4 v15, s[60:63], s22 offen offset:0 lds
  s_add_u32 s24, s24, 1
  s_cmp_eq_u32 s24, 3
  s_cselect_b32 s24, 0, s24
  s_add_u32 s23, s23, 1
  s_add_u32 s22, s22, 163840
  s_cmp_eq_u32 s23, 5
  s_cselect_b32 s8, 819200, 0
  s_cselect_b32 s23, 0, s23
  s_sub_u32 s22, s22, s8
  s_mul_i32 s8, s24, 20480
  s_add_u32 m0, s8, s34
  s_nop 0
  buffer_load_dwordx4 v11, s[60:63], s22 offen offset:0 lds
  buffer_load_dwordx4 v12, s[60:63], s22 offen offset:1024 lds
  buffer_load_dwordx4 v13, s[60:63], s22 offen offset:2048 lds
  buffer_load_dwordx4 v14, s[60:63], s22 offen offset:3072 lds
  s_add_u32 m0, m0, 4096
  s_nop 0
  buffer_load_dwordx4 v15, s[60:63], s22 offen offset:0 lds
  s_add_u32 s24, s24, 1
  s_cmp_eq_u32 s24, 3
  s_cselect_b32 s24, 0, s24
  s_add_u32 s23, s23, 1
  s_add_u32 s22, s22, 163840
  s_cmp_eq_u32 s23, 5
  s_cselect_b32 s8, 819200, 0
  s_cselect_b32 s23, 0, s23
  s_sub_u32 s22, s22, s8
  s_waitcnt vmcnt(21)
  s_waitcnt lgkmcnt(0)
  s_barrier
  s_mov_b32 s64, s38
  s_and_b32 s65, s39, 0xffff
  s_mov_b32 s66, 819200
  s_mov_b32 s67, 0x00020000
  s_mov_b32 s68, s40
  s_and_b32 s69, s41, 0xffff
  s_mov_b32 s70, 1966080
  s_mov_b32 s71, 0x00020000
  s_mov_b32 s72, s42
  s_and_b32 s73, s43, 0xffff
  s_mov_b32 s74, 1966080
  s_mov_b32 s75, 0x00020000
  s_mov_b32 s80, s26
  s_and_b32 s81, s27, 0xffff
  s_mov_b32 s82, 819200
  s_mov_b32 s83, 0x00020000
  s_mov_b32 s86, 819200
  s_mov_b32 s87, 0x00020000
  s_and_b32 s33, s29, 0xffff
  s_and_b32 s32, s27, 0xffff
  s_mov_b32 s84, s28
  s_mov_b32 s85, s33
  s_and_b32 s8, s2, 7
  s_and_b32 s9, s5, 3
  s_lshl_b32 s10, s9, 1
  s_add_u32 s10, s10, s4
  s_mul_i32 s11, s8, 3
  s_add_u32 s10, s10, s11
  s_mul_i32 s11, s10, 205
  s_lshr_b32 s11, s11, 11
  s_mul_i32 s11, s11, 10
  s_sub_u32 s38, s10, s11
  s_mul_i32 s10, s9, 3
  s_add_u32 s10, s10, s4
  s_add_u32 s10, s10, s8
  s_mul_i32 s11, s10, 171
  s_lshr_b32 s11, s11, 11
  s_mul_i32 s11, s11, 12
  s_sub_u32 s39, s10, s11
  s_and_b32 s9, s51, 1
  s_mul_i32 s9, s9, 40
  s_mul_i32 s10, s4, 80
  s_add_u32 s9, s9, s10
  s_mul_i32 s89, s9, 1280
  s_lshr_b32 s11, s51, 1
  s_lshl_b32 s12, s11, 7
  s_add_u32 s90, s89, s12
  s_mul_i32 s91, s11, 98304
  s_mul_i32 s8, s4, 384
  s_add_u32 s91, s91, s8
  s_mul_i32 s35, s51, 6144
  s_add_u32 s35, s35, 81920
  s_lshl_b32 s92, s51, 12
  s_mul_i32 s93, s5, 81920
  v_lshlrev_b32 v10, 4, v0
  v_add_u32 v10, s92, v10
  v_lshrrev_b32 v27, 3, v0
  v_and_b32 v28, 7, v0
  v_and_b32 v29, 6, v27
  v_xor_b32 v28, v28, v29
  v_mul_u32_u24 v27, 1280, v27
  v_lshl_add_u32 v27, v28, 4, v27
  v_add_u32 v16, 0, v27
  v_add_u32 v17, 9216, v27
  v_add_u32 v18, 18432, v27
  v_add_u32 v19, 27648, v27
  v_add_u32 v20, 40960, v27
  s_waitcnt vmcnt(5)
  s_barrier
  s_mul_i32 s8, s24, 20480
  s_add_u32 m0, s8, s34
  s_nop 0
  buffer_load_dwordx4 v11, s[60:63], s22 offen offset:0 lds
  buffer_load_dwordx4 v12, s[60:63], s22 offen offset:1024 lds
  buffer_load_dwordx4 v13, s[60:63], s22 offen offset:2048 lds
  buffer_load_dwordx4 v14, s[60:63], s22 offen offset:3072 lds
  s_add_u32 m0, m0, 4096
  s_nop 0
  buffer_load_dwordx4 v15, s[60:63], s22 offen offset:0 lds
  s_add_u32 s24, s24, 1
  s_cmp_eq_u32 s24, 3
  s_cselect_b32 s24, 0, s24
  s_add_u32 s23, s23, 1
  s_add_u32 s22, s22, 163840
  s_cmp_eq_u32 s23, 5
  s_cselect_b32 s8, 819200, 0
  s_cselect_b32 s23, 0, s23
  s_sub_u32 s22, s22, s8
  v_lshlrev_b32 v220, 16, v220
  v_lshlrev_b32 v221, 16, v221
  v_lshlrev_b32 v222, 16, v222
  v_mul_f32 v222, 0x3fb8aa3b, v222
  v_exp_f32 v222, v222
  s_nop 0
  v_cvt_pk_bf16_f32 v222, v222, v222
  v_lshlrev_b32 v222, 16, v222
  v_lshlrev_b32 v223, 16, v223
  v_lshlrev_b32 v224, 16, v224
  v_lshlrev_b32 v225, 16, v225
  v_mul_f32 v225, 0x3fb8aa3b, v225
  v_exp_f32 v225, v225
  s_nop 0
  v_cvt_pk_bf16_f32 v225, v225, v225
  v_lshlrev_b32 v225, 16, v225
  v_mul_f32 v236, v222, v220
  v_mul_f32 v237, v222, v221
  v_mul_f32 v242, v225, v223
  v_mul_f32 v243, v225, v224
  v_bfe_u32 v244, v227, 3, 1
  v_cvt_f32_u32 v244, v244
  v_fma_f32 v244, v244, 2.0, -1.0
  v_mul_f32 v28, 0x3fb8aa3b, v236
  v_mul_f32 v29, 0x3e22f983, v237
  v_exp_f32 v28, v28
  v_fract_f32 v29, v29
  v_cos_f32 v232, v29
  v_sin_f32 v233, v29
  v_mul_f32 v232, v232, v28
  v_mul_f32 v233, v233, v28
  v_mul_f32 v28, 0x4138aa3b, v236
  v_mul_f32 v29, 0x3fa2f983, v237
  v_exp_f32 v28, v28
  v_fract_f32 v29, v29
  v_cos_f32 v234, v29
  v_sin_f32 v235, v29
  v_mul_f32 v234, v234, v28
  v_mul_f32 v235, v235, v28
  v_mul_f32 v28, 0x42b8aa3b, v242
  v_mul_f32 v29, 0x4122f983, v243
  v_exp_f32 v28, v28
  v_fract_f32 v29, v29
  v_cos_f32 v240, v29
  v_sin_f32 v241, v29
  v_mul_f32 v240, v240, v28
  v_mul_f32 v241, v241, v28
  v_add_f32 v28, -1.0, v232
  v_mul_f32 v29, v220, v220
  v_fmac_f32 v29, v221, v221
  v_rcp_f32 v29, v29
  v_mul_f32 v30, v28, v220
  v_fmac_f32 v30, v233, v221
  v_mul_f32 v31, v233, v220
  v_fma_f32 v31, -v28, v221, v31
  v_mul_f32 v29, -2.0, v29
  v_mul_f32 v239, v31, v29
  v_mul_f32 v30, v30, v29
  v_mul_f32 v238, v30, v244
  v_mul_f32 v233, v233, v244
  v_mul_f32 v235, v235, v244
  v_lshlrev_b32 v28, 5, v227
  v_add_u32 v28, 143360, v28
  v_cmp_gt_u32 vcc, 40, v0
  s_nop 3
  s_and_saveexec_b64 s[94:95], vcc
  ds_write_b128 v28, v[232:235]
  ds_write_b128 v28, v[236:239] offset:16
  s_mov_b64 exec, s[94:95]
  s_waitcnt lgkmcnt(0)
  v_lshlrev_b32 v120, 4, v0
  v_add_u32 v121, 4096, v120
  buffer_store_dwordx4 v[156:159], v120, s[52:55], s47 offen offset:0 sc1
  buffer_store_dwordx4 v[160:163], v120, s[52:55], s47 offen offset:1024 sc1
  buffer_store_dwordx4 v[164:167], v120, s[52:55], s47 offen offset:2048 sc1
  buffer_store_dwordx4 v[168:171], v120, s[52:55], s47 offen offset:3072 sc1
  buffer_store_dwordx4 v[172:175], v121, s[52:55], s47 offen offset:0 sc1
  s_waitcnt vmcnt(10)
  s_barrier
  v_and_b32 v58, 31, v0
  v_lshlrev_b32 v58, 10, v58
  s_and_b32 s8, s2, 7
  s_lshl_b32 s8, s8, 7
  v_add_u32 v58, s8, v58
  s_mov_b32 s9, 196608
  buffer_load_dword v62, v58, s[52:55], s9 offen sc1
  s_mul_i32 s8, s24, 20480
  s_add_u32 m0, s8, s34
  s_nop 0
  buffer_load_dwordx4 v11, s[60:63], s22 offen offset:0 lds
  buffer_load_dwordx4 v12, s[60:63], s22 offen offset:1024 lds
  buffer_load_dwordx4 v13, s[60:63], s22 offen offset:2048 lds
  buffer_load_dwordx4 v14, s[60:63], s22 offen offset:3072 lds
  s_add_u32 m0, m0, 4096
  s_nop 0
  buffer_load_dwordx4 v15, s[60:63], s22 offen offset:0 lds
  s_add_u32 s24, s24, 1
  s_cmp_eq_u32 s24, 3
  s_cselect_b32 s24, 0, s24
  s_add_u32 s23, s23, 1
  s_add_u32 s22, s22, 163840
  s_cmp_eq_u32 s23, 5
  s_cselect_b32 s8, 819200, 0
  s_cselect_b32 s23, 0, s23
  s_sub_u32 s22, s22, s8
  s_waitcnt vmcnt(11)
  s_barrier
  s_lshl_b32 s23, s13, 1
  s_mul_i32 s22, s23, 128
  s_add_u32 s22, s22, s89
  s_mul_i32 s8, s24, 20480
  s_add_u32 m0, s8, s34
  s_nop 0
  buffer_load_dwordx4 v16, s[76:79], s22 offen offset:0 lds
  buffer_load_dwordx4 v17, s[76:79], s22 offen offset:1024 lds
  buffer_load_dwordx4 v18, s[76:79], s22 offen offset:2048 lds
  buffer_load_dwordx4 v19, s[76:79], s22 offen offset:3072 lds
  s_add_u32 m0, m0, 4096
  s_nop 0
  buffer_load_dwordx4 v20, s[76:79], s22 offen offset:0 lds
  s_add_u32 s24, s24, 1
  s_cmp_eq_u32 s24, 3
  s_cselect_b32 s24, 0, s24
  s_add_u32 s23, s23, 1
  s_add_u32 s22, s22, 128
  s_cmp_eq_u32 s23, 10
  s_cselect_b32 s8, 1280, 0
  s_cselect_b32 s23, 0, s23
  s_sub_u32 s22, s22, s8
  s_waitcnt vmcnt(5)
  s_barrier
  s_mul_i32 s8, s24, 20480
  s_add_u32 m0, s8, s34
  s_nop 0
  buffer_load_dwordx4 v16, s[76:79], s22 offen offset:0 lds
  buffer_load_dwordx4 v17, s[76:79], s22 offen offset:1024 lds
  buffer_load_dwordx4 v18, s[76:79], s22 offen offset:2048 lds
  buffer_load_dwordx4 v19, s[76:79], s22 offen offset:3072 lds
  s_add_u32 m0, m0, 4096
  s_nop 0
  buffer_load_dwordx4 v20, s[76:79], s22 offen offset:0 lds
  s_add_u32 s24, s24, 1
  s_cmp_eq_u32 s24, 3
  s_cselect_b32 s24, 0, s24
  s_add_u32 s23, s23, 1
  s_add_u32 s22, s22, 128
  s_cmp_eq_u32 s23, 10
  s_cselect_b32 s8, 1280, 0
  s_cselect_b32 s23, 0, s23
  s_sub_u32 s22, s22, s8
  s_mov_b32 s12, 0
  s_mov_b32 s9, 196608
  s_branch L_mode1
L_mode:
  buffer_load_dword v62, v58, s[52:55], s9 offen sc1
  s_waitcnt vmcnt(0)
L_mode1:
  s_add_u32 s12, s12, 1
  v_subrev_u32 v30, s7, v62
  v_cmp_lt_u32 vcc, 7, v30
  s_nop 4
  s_cbranch_vccz L_moded
  s_cmp_lt_u32 s12, 0x8000
  s_cbranch_scc1 L_mode
L_moded:
  v_readfirstlane_b32 s98, v30
  s_mov_b32 s100, 1
  s_nop 0
  v_cmp_ne_u32 vcc, s98, v30
  s_nop 4
  s_cbranch_vccz L_modee
  s_mov_b32 s100, 2
L_modee:
  v_mov_b32 v30, s100
  v_mov_b32 v27, 157068
  s_mov_b64 exec, 1
  ds_write_b32 v27, v30
  s_mov_b64 exec, -1
  s_waitcnt lgkmcnt(0)
  s_barrier
  s_mul_i32 s8, s24, 20480
  s_add_u32 m0, s8, s34
  s_nop 0
  buffer_load_dwordx4 v16, s[76:79], s22 offen offset:0 lds
  buffer_load_dwordx4 v17, s[76:79], s22 offen offset:1024 lds
  buffer_load_dwordx4 v18, s[76:79], s22 offen offset:2048 lds
  buffer_load_dwordx4 v19, s[76:79], s22 offen offset:3072 lds
  s_add_u32 m0, m0, 4096
  s_nop 0
  buffer_load_dwordx4 v20, s[76:79], s22 offen offset:0 lds
  s_add_u32 s24, s24, 1
  s_cmp_eq_u32 s24, 3
  s_cselect_b32 s24, 0, s24
  s_add_u32 s23, s23, 1
  s_add_u32 s22, s22, 128
  s_cmp_eq_u32 s23, 10
  s_cselect_b32 s8, 1280, 0
  s_cselect_b32 s23, 0, s23
  s_sub_u32 s22, s22, s8
  s_and_b32 s9, s51, 1
  s_mul_i32 s9, s9, 384
  v_add_u32 v27, 0, v0
  v_add_u32 v27, s9, v27
  v_mul_u32_u24 v28, 2731, v27
  v_lshrrev_b32 v28, 16, v28
  v_mul_u32_u24 v29, 24, v28
  v_sub_u32 v29, v27, v29
  v_and_b32 v31, 6, v28
  v_xor_b32 v29, v29, v31
  v_and_b32 v30, 0x13, v28
  v_and_b32 v31, 8, v28
  v_lshrrev_b32 v31, 1, v31
  v_or_b32 v30, v30, v31
  v_and_b32 v31, 4, v28
  v_lshlrev_b32 v31, 1, v31
  v_or_b32 v30, v30, v31
  v_mul_u32_u24 v30, 3072, v30
  v_lshl_add_u32 v21, v29, 4, v30
  v_add_u32 v27, 64, v0
  v_add_u32 v27, s9, v27
  v_mul_u32_u24 v28, 2731, v27
  v_lshrrev_b32 v28, 16, v28
  v_mul_u32_u24 v29, 24, v28
  v_sub_u32 v29, v27, v29
  v_and_b32 v31, 6, v28
  v_xor_b32 v29, v29, v31
  v_and_b32 v30, 0x13, v28
  v_and_b32 v31, 8, v28
  v_lshrrev_b32 v31, 1, v31
  v_or_b32 v30, v30, v31
  v_and_b32 v31, 4, v28
  v_lshlrev_b32 v31, 1, v31
  v_or_b32 v30, v30, v31
  v_mul_u32_u24 v30, 3072, v30
  v_lshl_add_u32 v22, v29, 4, v30
  v_subrev_u32 v22, 1024, v22
  v_add_u32 v27, 128, v0
  v_add_u32 v27, s9, v27
  v_mul_u32_u24 v28, 2731, v27
  v_lshrrev_b32 v28, 16, v28
  v_mul_u32_u24 v29, 24, v28
  v_sub_u32 v29, v27, v29
  v_and_b32 v31, 6, v28
  v_xor_b32 v29, v29, v31
  v_and_b32 v30, 0x13, v28
  v_and_b32 v31, 8, v28
  v_lshrrev_b32 v31, 1, v31
  v_or_b32 v30, v30, v31
  v_and_b32 v31, 4, v28
  v_lshlrev_b32 v31, 1, v31
  v_or_b32 v30, v30, v31
  v_mul_u32_u24 v30, 3072, v30
  v_lshl_add_u32 v23, v29, 4, v30
  v_subrev_u32 v23, 2048, v23
  v_add_u32 v27, 192, v0
  v_add_u32 v27, s9, v27
  v_mul_u32_u24 v28, 2731, v27
  v_lshrrev_b32 v28, 16, v28
  v_mul_u32_u24 v29, 24, v28
  v_sub_u32 v29, v27, v29
  v_and_b32 v31, 6, v28
  v_xor_b32 v29, v29, v31
  v_and_b32 v30, 0x13, v28
  v_and_b32 v31, 8, v28
  v_lshrrev_b32 v31, 1, v31
  v_or_b32 v30, v30, v31
  v_and_b32 v31, 4, v28
  v_lshlrev_b32 v31, 1, v31
  v_or_b32 v30, v30, v31
  v_mul_u32_u24 v30, 3072, v30
  v_lshl_add_u32 v24, v29, 4, v30
  v_subrev_u32 v24, 3072, v24
  v_add_u32 v27, 256, v0
  v_add_u32 v27, s9, v27
  v_mul_u32_u24 v28, 2731, v27
  v_lshrrev_b32 v28, 16, v28
  v_mul_u32_u24 v29, 24, v28
  v_sub_u32 v29, v27, v29
  v_and_b32 v31, 6, v28
  v_xor_b32 v29, v29, v31
  v_and_b32 v30, 0x13, v28
  v_and_b32 v31, 8, v28
  v_lshrrev_b32 v31, 1, v31
  v_or_b32 v30, v30, v31
  v_and_b32 v31, 4, v28
  v_lshlrev_b32 v31, 1, v31
  v_or_b32 v30, v30, v31
  v_mul_u32_u24 v30, 3072, v30
  v_lshl_add_u32 v25, v29, 4, v30
  v_add_u32 v27, 320, v0
  v_add_u32 v27, s9, v27
  v_mul_u32_u24 v28, 2731, v27
  v_lshrrev_b32 v28, 16, v28
  v_mul_u32_u24 v29, 24, v28
  v_sub_u32 v29, v27, v29
  v_and_b32 v31, 6, v28
  v_xor_b32 v29, v29, v31
  v_and_b32 v30, 0x13, v28
  v_and_b32 v31, 8, v28
  v_lshrrev_b32 v31, 1, v31
  v_or_b32 v30, v30, v31
  v_and_b32 v31, 4, v28
  v_lshlrev_b32 v31, 1, v31
  v_or_b32 v30, v30, v31
  v_mul_u32_u24 v30, 3072, v30
  v_lshl_add_u32 v26, v29, 4, v30
  v_subrev_u32 v26, 1024, v26
  s_lshl_b32 s8, s51, 8
  s_add_u32 s8, s8, s2
  s_mul_i32 s9, s8, 1366
  s_lshr_b32 s9, s9, 16
  s_mul_i32 s10, s9, 48
  s_sub_u32 s10, s8, s10
  s_lshl_b32 s9, s9, 8
  s_lshl_b32 s10, s10, 2
  s_add_u32 s9, s9, s10
  s_add_u32 s9, s9, 229376
  s_cmp_lt_u32 s8, 384
  s_cselect_b32 s9, s9, 2147483632
  v_mov_b32 v120, s7
  v_mov_b32 v121, 0
  s_mov_b64 exec, 1
  buffer_store_dword v120, v121, s[52:55], s9 offen sc1
  s_mov_b64 exec, -1
  s_waitcnt vmcnt(11)
  s_barrier
  s_waitcnt vmcnt(6)
  s_barrier
  s_mul_i32 s8, s24, 20480
  s_add_u32 m0, s8, s34
  s_nop 0
  buffer_load_dwordx4 v16, s[76:79], s22 offen offset:0 lds
  buffer_load_dwordx4 v17, s[76:79], s22 offen offset:1024 lds
  buffer_load_dwordx4 v18, s[76:79], s22 offen offset:2048 lds
  buffer_load_dwordx4 v19, s[76:79], s22 offen offset:3072 lds
  s_add_u32 m0, m0, 4096
  s_nop 0
  buffer_load_dwordx4 v20, s[76:79], s22 offen offset:0 lds
  s_add_u32 s24, s24, 1
  s_cmp_eq_u32 s24, 3
  s_cselect_b32 s24, 0, s24
  s_add_u32 s23, s23, 1
  s_add_u32 s22, s22, 128
  s_cmp_eq_u32 s23, 10
  s_cselect_b32 s8, 1280, 0
  s_cselect_b32 s23, 0, s23
  s_sub_u32 s22, s22, s8
  s_waitcnt vmcnt(6)
  s_barrier
  s_mul_i32 s8, s24, 20480
  s_add_u32 m0, s8, s34
  s_nop 0
  buffer_load_dwordx4 v16, s[76:79], s22 offen offset:0 lds
  buffer_load_dwordx4 v17, s[76:79], s22 offen offset:1024 lds
  buffer_load_dwordx4 v18, s[76:79], s22 offen offset:2048 lds
  buffer_load_dwordx4 v19, s[76:79], s22 offen offset:3072 lds
  s_add_u32 m0, m0, 4096
  s_nop 0
  buffer_load_dwordx4 v20, s[76:79], s22 offen offset:0 lds
  s_add_u32 s24, s24, 1
  s_cmp_eq_u32 s24, 3
  s_cselect_b32 s24, 0, s24
  s_add_u32 s23, s23, 1
  s_add_u32 s22, s22, 128
  s_cmp_eq_u32 s23, 10
  s_cselect_b32 s8, 1280, 0
  s_cselect_b32 s23, 0, s23
  s_sub_u32 s22, s22, s8
  s_mov_b32 s101, 4
L_ll_g8:
  s_waitcnt vmcnt(5)
  s_barrier
  s_mul_i32 s8, s24, 20480
  s_add_u32 m0, s8, s34
  s_nop 0
  buffer_load_dwordx4 v16, s[76:79], s22 offen offset:0 lds
  buffer_load_dwordx4 v17, s[76:79], s22 offen offset:1024 lds
  buffer_load_dwordx4 v18, s[76:79], s22 offen offset:2048 lds
  buffer_load_dwordx4 v19, s[76:79], s22 offen offset:3072 lds
  s_add_u32 m0, m0, 4096
  s_nop 0
  buffer_load_dwordx4 v20, s[76:79], s22 offen offset:0 lds
  s_add_u32 s24, s24, 1
  s_cmp_eq_u32 s24, 3
  s_cselect_b32 s24, 0, s24
  s_add_u32 s23, s23, 1
  s_add_u32 s22, s22, 128
  s_cmp_eq_u32 s23, 10
  s_cselect_b32 s8, 1280, 0
  s_cselect_b32 s23, 0, s23
  s_sub_u32 s22, s22, s8
  s_sub_u32 s101, s101, 1
  s_cmp_lg_u32 s101, 0
  s_cbranch_scc1 L_ll_g8
  s_waitcnt vmcnt(5)
  s_barrier
  s_mul_i32 s8, s24, 20480
  s_add_u32 m0, s8, s34
  s_nop 0
  buffer_load_dwordx4 v16, s[76:79], s22 offen offset:0 lds
  buffer_load_dwordx4 v17, s[76:79], s22 offen offset:1024 lds
  buffer_load_dwordx4 v18, s[76:79], s22 offen offset:2048 lds
  buffer_load_dwordx4 v19, s[76:79], s22 offen offset:3072 lds
  s_add_u32 m0, m0, 4096
  s_nop 0
  buffer_load_dwordx4 v20, s[76:79], s22 offen offset:0 lds
  s_add_u32 s24, s24, 1
  s_cmp_eq_u32 s24, 3
  s_cselect_b32 s24, 0, s24
  s_add_u32 s23, s23, 1
  s_add_u32 s22, s22, 128
  s_cmp_eq_u32 s23, 10
  s_cselect_b32 s8, 1280, 0
  s_cselect_b32 s23, 0, s23
  s_sub_u32 s22, s22, s8
  v_and_b32 v61, 31, v0
  v_lshrrev_b32 v33, 2, v61
  v_and_b32 v61, 3, v61
  v_lshlrev_b32 v61, 2, v61
  v_lshl_add_u32 v61, v33, 7, v61
  s_lshl_b32 s8, s5, 10
  v_add_u32 v61, s8, v61
  v_and_b32 v33, 7, v0
  v_lshlrev_b32 v33, 7, v33
  s_max_u32 s9, s5, 1
  s_sub_u32 s9, s9, 1
  s_lshl_b32 s9, s9, 10
  s_add_u32 s9, s9, 12
  v_add_u32 v34, s9, v33
  s_add_u32 s9, s5, 1
  s_min_u32 s9, s9, 31
  s_lshl_b32 s9, s9, 10
  v_add_u32 v35, s9, v33
  v_lshrrev_b32 v33, 3, v0
  v_cmp_eq_u32 vcc, 4, v33
  s_nop 1
  v_cndmask_b32 v61, v61, v34, vcc
  v_cmp_eq_u32 vcc, 5, v33
  s_nop 1
  v_cndmask_b32 v61, v61, v35, vcc
  s_mov_b32 s10, 65536
  buffer_load_dword v60, v61, s[52:55], s10 offen sc1
  s_waitcnt vmcnt(6)
  s_barrier
  s_mov_b32 s23, s13
  s_mul_i32 s22, s23, 163840
  s_add_u32 s22, s22, s88
  s_mul_i32 s8, s24, 20480
  s_add_u32 m0, s8, s34
  s_nop 0
  buffer_load_dwordx4 v11, s[64:67], s22 offen offset:0 lds
  buffer_load_dwordx4 v12, s[64:67], s22 offen offset:1024 lds
  buffer_load_dwordx4 v13, s[64:67], s22 offen offset:2048 lds
  buffer_load_dwordx4 v14, s[64:67], s22 offen offset:3072 lds
  s_add_u32 m0, m0, 4096
  s_nop 0
  buffer_load_dwordx4 v15, s[64:67], s22 offen offset:0 lds
  s_add_u32 s24, s24, 1
  s_cmp_eq_u32 s24, 3
  s_cselect_b32 s24, 0, s24
  s_add_u32 s23, s23, 1
  s_add_u32 s22, s22, 163840
  s_cmp_eq_u32 s23, 5
  s_cselect_b32 s8, 819200, 0
  s_cselect_b32 s23, 0, s23
  s_sub_u32 s22, s22, s8
  s_waitcnt vmcnt(6)
  s_barrier
  s_mul_i32 s8, s24, 20480
  s_add_u32 m0, s8, s34
  s_nop 0
  buffer_load_dwordx4 v11, s[64:67], s22 offen offset:0 lds
  buffer_load_dwordx4 v12, s[64:67], s22 offen offset:1024 lds
  buffer_load_dwordx4 v13, s[64:67], s22 offen offset:2048 lds
  buffer_load_dwordx4 v14, s[64:67], s22 offen offset:3072 lds
  s_add_u32 m0, m0, 4096
  s_nop 0
  buffer_load_dwordx4 v15, s[64:67], s22 offen offset:0 lds
  s_add_u32 s24, s24, 1
  s_cmp_eq_u32 s24, 3
  s_cselect_b32 s24, 0, s24
  s_add_u32 s23, s23, 1
  s_add_u32 s22, s22, 163840
  s_cmp_eq_u32 s23, 5
  s_cselect_b32 s8, 819200, 0
  s_cselect_b32 s23, 0, s23
  s_sub_u32 s22, s22, s8
  s_barrier
  v_cmp_ne_u32 vcc, s7, v60
  s_nop 4
  s_cbranch_vccz L_f1ok
  s_mov_b32 s10, 65536
  s_mov_b32 s11, 0
L_f1poll:
  buffer_load_dword v60, v61, s[52:55], s10 offen sc1
  s_add_u32 s11, s11, 1
  s_waitcnt vmcnt(0)
  v_cmp_ne_u32 vcc, s7, v60
  s_nop 4
  s_cbranch_vccz L_f1ok
  s_cmp_lt_u32 s11, 0x8000
  s_cbranch_scc1 L_f1poll
L_f1ok:
  s_mul_i32 s25, s13, 16384
  s_mul_i32 s8, s5, 81920
  s_add_u32 s25, s25, s8
  s_add_u32 s25, s25, 1048576
  s_mov_b32 s36, s13
  s_mov_b32 s37, 0
  s_add_u32 m0, s37, s92
  s_nop 0
  buffer_load_dwordx4 v10, s[52:55], s25 offen offset:0 sc1 lds
  buffer_load_dwordx4 v10, s[52:55], s25 offen offset:1024 sc1 lds
  buffer_load_dwordx4 v10, s[52:55], s25 offen offset:2048 sc1 lds
  buffer_load_dwordx4 v10, s[52:55], s25 offen offset:3072 sc1 lds
  s_add_u32 s36, s36, 1
  s_add_u32 s25, s25, 16384
  s_cmp_eq_u32 s36, 5
  s_cselect_b32 s8, 81920, 0
  s_cselect_b32 s36, 0, s36
  s_sub_u32 s25, s25, s8
  s_add_u32 s37, s37, 16384
  s_cmp_eq_u32 s37, 81920
  s_cselect_b32 s37, 0, s37
  s_add_u32 m0, s37, s92
  s_nop 0
  buffer_load_dwordx4 v10, s[52:55], s25 offen offset:0 sc1 lds
  buffer_load_dwordx4 v10, s[52:55], s25 offen offset:1024 sc1 lds
  buffer_load_dwordx4 v10, s[52:55], s25 offen offset:2048 sc1 lds
  buffer_load_dwordx4 v10, s[52:55], s25 offen offset:3072 sc1 lds
  s_add_u32 s36, s36, 1
  s_add_u32 s25, s25, 16384
  s_cmp_eq_u32 s36, 5
  s_cselect_b32 s8, 81920, 0
  s_cselect_b32 s36, 0, s36
  s_sub_u32 s25, s25, s8
  s_add_u32 s37, s37, 16384
  s_cmp_eq_u32 s37, 81920
  s_cselect_b32 s37, 0, s37
  s_mul_i32 s8, s24, 20480
  s_add_u32 m0, s8, s34
  s_nop 0
  buffer_load_dwordx4 v11, s[64:67], s22 offen offset:0 lds
  buffer_load_dwordx4 v12, s[64:67], s22 offen offset:1024 lds
  buffer_load_dwordx4 v13, s[64:67], s22 offen offset:2048 lds
  buffer_load_dwordx4 v14, s[64:67], s22 offen offset:3072 lds
  s_add_u32 m0, m0, 4096
  s_nop 0
  buffer_load_dwordx4 v15, s[64:67], s22 offen offset:0 lds
  s_add_u32 s24, s24, 1
  s_cmp_eq_u32 s24, 3
  s_cselect_b32 s24, 0, s24
  s_add_u32 s23, s23, 1
  s_add_u32 s22, s22, 163840
  s_cmp_eq_u32 s23, 5
  s_cselect_b32 s8, 819200, 0
  s_cselect_b32 s23, 0, s23
  s_sub_u32 s22, s22, s8
  s_waitcnt vmcnt(9)
  s_barrier
  s_add_u32 m0, s37, s92
  s_nop 0
  buffer_load_dwordx4 v10, s[52:55], s25 offen offset:0 sc1 lds
  buffer_load_dwordx4 v10, s[52:55], s25 offen offset:1024 sc1 lds
  buffer_load_dwordx4 v10, s[52:55], s25 offen offset:2048 sc1 lds
  buffer_load_dwordx4 v10, s[52:55], s25 offen offset:3072 sc1 lds
  s_add_u32 s36, s36, 1
  s_add_u32 s25, s25, 16384
  s_cmp_eq_u32 s36, 5
  s_cselect_b32 s8, 81920, 0
  s_cselect_b32 s36, 0, s36
  s_sub_u32 s25, s25, s8
  s_add_u32 s37, s37, 16384
  s_cmp_eq_u32 s37, 81920
  s_cselect_b32 s37, 0, s37
  s_add_u32 m0, s37, s92
  s_nop 0
  buffer_load_dwordx4 v10, s[52:55], s25 offen offset:0 sc1 lds
  buffer_load_dwordx4 v10, s[52:55], s25 offen offset:1024 sc1 lds
  buffer_load_dwordx4 v10, s[52:55], s25 offen offset:2048 sc1 lds
  buffer_load_dwordx4 v10, s[52:55], s25 offen offset:3072 sc1 lds
  s_add_u32 s36, s36, 1
  s_add_u32 s25, s25, 16384
  s_cmp_eq_u32 s36, 5
  s_cselect_b32 s8, 81920, 0
  s_cselect_b32 s36, 0, s36
  s_sub_u32 s25, s25, s8
  s_add_u32 s37, s37, 16384
  s_cmp_eq_u32 s37, 81920
  s_cselect_b32 s37, 0, s37
  s_add_u32 m0, s37, s92
  s_nop 0
  buffer_load_dwordx4 v10, s[52:55], s25 offen offset:0 sc1 lds
  buffer_load_dwordx4 v10, s[52:55], s25 offen offset:1024 sc1 lds
  buffer_load_dwordx4 v10, s[52:55], s25 offen offset:2048 sc1 lds
  buffer_load_dwordx4 v10, s[52:55], s25 offen offset:3072 sc1 lds
  s_add_u32 s36, s36, 1
  s_add_u32 s25, s25, 16384
  s_cmp_eq_u32 s36, 5
  s_cselect_b32 s8, 81920, 0
  s_cselect_b32 s36, 0, s36
  s_sub_u32 s25, s25, s8
  s_add_u32 s37, s37, 16384
  s_cmp_eq_u32 s37, 81920
  s_cselect_b32 s37, 0, s37
  s_waitcnt vmcnt(17)
  s_barrier
  s_mul_i32 s8, s24, 20480
  s_add_u32 m0, s8, s34
  s_nop 0
  buffer_load_dwordx4 v11, s[64:67], s22 offen offset:0 lds
  buffer_load_dwordx4 v12, s[64:67], s22 offen offset:1024 lds
  buffer_load_dwordx4 v13, s[64:67], s22 offen offset:2048 lds
  buffer_load_dwordx4 v14, s[64:67], s22 offen offset:3072 lds
  s_add_u32 m0, m0, 4096
  s_nop 0
  buffer_load_dwordx4 v15, s[64:67], s22 offen offset:0 lds
  s_add_u32 s24, s24, 1
  s_cmp_eq_u32 s24, 3
  s_cselect_b32 s24, 0, s24
  s_add_u32 s23, s23, 1
  s_add_u32 s22, s22, 163840
  s_cmp_eq_u32 s23, 5
  s_cselect_b32 s8, 819200, 0
  s_cselect_b32 s23, 0, s23
  s_sub_u32 s22, s22, s8
  s_waitcnt vmcnt(13)
  s_barrier
  s_mul_i32 s8, s24, 20480
  s_add_u32 m0, s8, s34
  s_nop 0
  buffer_load_dwordx4 v11, s[64:67], s22 offen offset:0 lds
  buffer_load_dwordx4 v12, s[64:67], s22 offen offset:1024 lds
  buffer_load_dwordx4 v13, s[64:67], s22 offen offset:2048 lds
  buffer_load_dwordx4 v14, s[64:67], s22 offen offset:3072 lds
  s_add_u32 m0, m0, 4096
  s_nop 0
  buffer_load_dwordx4 v15, s[64:67], s22 offen offset:0 lds
  s_add_u32 s24, s24, 1
  s_cmp_eq_u32 s24, 3
  s_cselect_b32 s24, 0, s24
  s_add_u32 s23, s23, 1
  s_add_u32 s22, s22, 163840
  s_cmp_eq_u32 s23, 5
  s_cselect_b32 s8, 819200, 0
  s_cselect_b32 s23, 0, s23
  s_sub_u32 s22, s22, s8
  s_waitcnt vmcnt(5)
  s_barrier
  s_lshl_b32 s23, s13, 1
  s_mul_i32 s22, s23, 196608
  s_add_u32 s22, s22, s91
  s_mul_i32 s8, s24, 24576
  s_add_u32 m0, s8, s35
  s_nop 0
  buffer_load_dwordx4 v21, s[68:71], s22 offen offset:0 lds
  buffer_load_dwordx4 v22, s[68:71], s22 offen offset:1024 lds
  buffer_load_dwordx4 v23, s[68:71], s22 offen offset:2048 lds
  buffer_load_dwordx4 v24, s[68:71], s22 offen offset:3072 lds
  s_add_u32 m0, m0, 4096
  s_nop 0
  buffer_load_dwordx4 v25, s[68:71], s22 offen offset:0 lds
  buffer_load_dwordx4 v26, s[68:71], s22 offen offset:1024 lds
  s_add_u32 s24, s24, 1
  s_cmp_eq_u32 s24, 3
  s_cselect_b32 s24, 0, s24
  s_add_u32 s23, s23, 1
  s_add_u32 s22, s22, 196608
  s_cmp_eq_u32 s23, 10
  s_cselect_b32 s8, 1966080, 0
  s_cselect_b32 s23, 0, s23
  s_sub_u32 s22, s22, s8
  s_waitcnt vmcnt(6)
  s_barrier
  v_mul_u32_u24 v32, 11, v231
  v_lshlrev_b32 v33, 4, v230
  s_mul_i32 s45, s4, 1280
  s_add_u32 s45, s45, 262144
  v_mul_u32_u24 v34, 112640, v231
  v_add_u32 v33, v33, v34
  v_cmp_gt_u32 vcc, 60, v0
  v_mov_b32 v34, 0x100
  s_nop 0
  v_cndmask_b32 v32, v34, v32, vcc
  v_mov_b32 v37, 2147483632
  v_mov_b32 v88, v32
  v_mov_b32 v89, v33
  v_mov_b32 v90, v37
  v_add_u32 v35, 0, v32
  v_cmp_gt_u32 vcc, s5, v35
  v_add_u32 v36, 0, v33
  s_nop 0
  v_cndmask_b32 v36, v37, v36, vcc
  buffer_load_dwordx4 v[44:47], v36, s[52:55], s45 offen sc1
  v_add_u32 v35, 1, v32
  v_cmp_gt_u32 vcc, s5, v35
  v_add_u32 v36, 10240, v33
  s_nop 0
  v_cndmask_b32 v36, v37, v36, vcc
  buffer_load_dwordx4 v[48:51], v36, s[52:55], s45 offen sc1
  v_add_u32 v35, 2, v32
  v_cmp_gt_u32 vcc, s5, v35
  v_add_u32 v36, 20480, v33
  s_nop 0
  v_cndmask_b32 v36, v37, v36, vcc
  buffer_load_dwordx4 v[52:55], v36, s[52:55], s45 offen sc1
  v_add_u32 v35, 3, v32
  v_cmp_gt_u32 vcc, s5, v35
  v_add_u32 v36, 30720, v33
  s_nop 0
  v_cndmask_b32 v36, v37, v36, vcc
  buffer_load_dwordx4 v[56:59], v36, s[52:55], s45 offen sc1
  v_add_u32 v35, 4, v32
  v_cmp_gt_u32 vcc, s5, v35
  v_add_u32 v36, 40960, v33
  s_nop 0
  v_cndmask_b32 v36, v37, v36, vcc
  buffer_load_dwordx4 v[60:63], v36, s[52:55], s45 offen sc1
  v_add_u32 v35, 5, v32
  v_cmp_gt_u32 vcc, s5, v35
  v_add_u32 v36, 51200, v33
  s_nop 0
  v_cndmask_b32 v36, v37, v36, vcc
  buffer_load_dwordx4 v[64:67], v36, s[52:55], s45 offen sc1
  v_add_u32 v35, 6, v32
  v_cmp_gt_u32 vcc, s5, v35
  v_add_u32 v36, 61440, v33
  s_nop 0
  v_cndmask_b32 v36, v37, v36, vcc
  buffer_load_dwordx4 v[68:71], v36, s[52:55], s45 offen sc1
  v_add_u32 v35, 7, v32
  v_cmp_gt_u32 vcc, s5, v35
  v_add_u32 v36, 71680, v33
  s_nop 0
  v_cndmask_b32 v36, v37, v36, vcc
  buffer_load_dwordx4 v[72:75], v36, s[52:55], s45 offen sc1
  v_add_u32 v35, 8, v32
  v_cmp_gt_u32 vcc, s5, v35
  v_add_u32 v36, 81920, v33
  s_nop 0
  v_cndmask_b32 v36, v37, v36, vcc
  buffer_load_dwordx4 v[76:79], v36, s[52:55], s45 offen sc1
  v_add_u32 v35, 9, v32
  v_cmp_gt_u32 vcc, s5, v35
  v_add_u32 v36, 92160, v33
  s_nop 0
  v_cndmask_b32 v36, v37, v36, vcc
  buffer_load_dwordx4 v[80:83], v36, s[52:55], s45 offen sc1
  v_add_u32 v35, 10, v32
  v_cmp_gt_u32 vcc, s5, v35
  v_add_u32 v36, 102400, v33
  s_nop 0
  v_cndmask_b32 v36, v37, v36, vcc
  buffer_load_dwordx4 v[84:87], v36, s[52:55], s45 offen sc1
  s_barrier
  s_waitcnt vmcnt(0)
  v_mov_b32 v32, v88
  v_mov_b32 v33, v89
  v_mov_b32 v37, v90
  s_mov_b32 s11, 0
  s_branch L_pollE1
L_pollE:
  v_add_u32 v35, 0, v32
  v_cmp_gt_u32 vcc, s5, v35
  v_add_u32 v36, 0, v33
  s_nop 0
  v_cndmask_b32 v36, v37, v36, vcc
  buffer_load_dwordx4 v[44:47], v36, s[52:55], s45 offen sc1
  v_add_u32 v35, 1, v32
  v_cmp_gt_u32 vcc, s5, v35
  v_add_u32 v36, 10240, v33
  s_nop 0
  v_cndmask_b32 v36, v37, v36, vcc
  buffer_load_dwordx4 v[48:51], v36, s[52:55], s45 offen sc1
  v_add_u32 v35, 2, v32
  v_cmp_gt_u32 vcc, s5, v35
  v_add_u32 v36, 20480, v33
  s_nop 0
  v_cndmask_b32 v36, v37, v36, vcc
  buffer_load_dwordx4 v[52:55], v36, s[52:55], s45 offen sc1
  v_add_u32 v35, 3, v32
  v_cmp_gt_u32 vcc, s5, v35
  v_add_u32 v36, 30720, v33
  s_nop 0
  v_cndmask_b32 v36, v37, v36, vcc
  buffer_load_dwordx4 v[56:59], v36, s[52:55], s45 offen sc1
  v_add_u32 v35, 4, v32
  v_cmp_gt_u32 vcc, s5, v35
  v_add_u32 v36, 40960, v33
  s_nop 0
  v_cndmask_b32 v36, v37, v36, vcc
  buffer_load_dwordx4 v[60:63], v36, s[52:55], s45 offen sc1
  v_add_u32 v35, 5, v32
  v_cmp_gt_u32 vcc, s5, v35
  v_add_u32 v36, 51200, v33
  s_nop 0
  v_cndmask_b32 v36, v37, v36, vcc
  buffer_load_dwordx4 v[64:67], v36, s[52:55], s45 offen sc1
  v_add_u32 v35, 6, v32
  v_cmp_gt_u32 vcc, s5, v35
  v_add_u32 v36, 61440, v33
  s_nop 0
  v_cndmask_b32 v36, v37, v36, vcc
  buffer_load_dwordx4 v[68:71], v36, s[52:55], s45 offen sc1
  v_add_u32 v35, 7, v32
  v_cmp_gt_u32 vcc, s5, v35
  v_add_u32 v36, 71680, v33
  s_nop 0
  v_cndmask_b32 v36, v37, v36, vcc
  buffer_load_dwordx4 v[72:75], v36, s[52:55], s45 offen sc1
  v_add_u32 v35, 8, v32
  v_cmp_gt_u32 vcc, s5, v35
  v_add_u32 v36, 81920, v33
  s_nop 0
  v_cndmask_b32 v36, v37, v36, vcc
  buffer_load_dwordx4 v[76:79], v36, s[52:55], s45 offen sc1
  v_add_u32 v35, 9, v32
  v_cmp_gt_u32 vcc, s5, v35
  v_add_u32 v36, 92160, v33
  s_nop 0
  v_cndmask_b32 v36, v37, v36, vcc
  buffer_load_dwordx4 v[80:83], v36, s[52:55], s45 offen sc1
  v_add_u32 v35, 10, v32
  v_cmp_gt_u32 vcc, s5, v35
  v_add_u32 v36, 102400, v33
  s_nop 0
  v_cndmask_b32 v36, v37, v36, vcc
  buffer_load_dwordx4 v[84:87], v36, s[52:55], s45 offen sc1
  s_waitcnt vmcnt(0)
L_pollE1:
  s_mov_b64 s[96:97], 0
  v_add_u32 v35, 0, v32
  v_cmp_gt_u32 s[98:99], s5, v35
  v_xor_b32 v36, s7, v45
  v_xor_b32 v38, s7, v47
  v_or_b32 v36, v36, v38
  v_cmp_ne_u32 vcc, 0, v36
  s_nop 3
  s_and_b64 vcc, vcc, s[98:99]
  s_or_b64 s[96:97], s[96:97], vcc
  v_add_u32 v35, 1, v32
  v_cmp_gt_u32 s[98:99], s5, v35
  v_xor_b32 v36, s7, v49
  v_xor_b32 v38, s7, v51
  v_or_b32 v36, v36, v38
  v_cmp_ne_u32 vcc, 0, v36
  s_nop 3
  s_and_b64 vcc, vcc, s[98:99]
  s_or_b64 s[96:97], s[96:97], vcc
  v_add_u32 v35, 2, v32
  v_cmp_gt_u32 s[98:99], s5, v35
  v_xor_b32 v36, s7, v53
  v_xor_b32 v38, s7, v55
  v_or_b32 v36, v36, v38
  v_cmp_ne_u32 vcc, 0, v36
  s_nop 3
  s_and_b64 vcc, vcc, s[98:99]
  s_or_b64 s[96:97], s[96:97], vcc
  v_add_u32 v35, 3, v32
  v_cmp_gt_u32 s[98:99], s5, v35
  v_xor_b32 v36, s7, v57
  v_xor_b32 v38, s7, v59
  v_or_b32 v36, v36, v38
  v_cmp_ne_u32 vcc, 0, v36
  s_nop 3
  s_and_b64 vcc, vcc, s[98:99]
  s_or_b64 s[96:97], s[96:97], vcc
  v_add_u32 v35, 4, v32
  v_cmp_gt_u32 s[98:99], s5, v35
  v_xor_b32 v36, s7, v61
  v_xor_b32 v38, s7, v63
  v_or_b32 v36, v36, v38
  v_cmp_ne_u32 vcc, 0, v36
  s_nop 3
  s_and_b64 vcc, vcc, s[98:99]
  s_or_b64 s[96:97], s[96:97], vcc
  v_add_u32 v35, 5, v32
  v_cmp_gt_u32 s[98:99], s5, v35
  v_xor_b32 v36, s7, v65
  v_xor_b32 v38, s7, v67
  v_or_b32 v36, v36, v38
  v_cmp_ne_u32 vcc, 0, v36
  s_nop 3
  s_and_b64 vcc, vcc, s[98:99]
  s_or_b64 s[96:97], s[96:97], vcc
  v_add_u32 v35, 6, v32
  v_cmp_gt_u32 s[98:99], s5, v35
  v_xor_b32 v36, s7, v69
  v_xor_b32 v38, s7, v71
  v_or_b32 v36, v36, v38
  v_cmp_ne_u32 vcc, 0, v36
  s_nop 3
  s_and_b64 vcc, vcc, s[98:99]
  s_or_b64 s[96:97], s[96:97], vcc
  v_add_u32 v35, 7, v32
  v_cmp_gt_u32 s[98:99], s5, v35
  v_xor_b32 v36, s7, v73
  v_xor_b32 v38, s7, v75
  v_or_b32 v36, v36, v38
  v_cmp_ne_u32 vcc, 0, v36
  s_nop 3
  s_and_b64 vcc, vcc, s[98:99]
  s_or_b64 s[96:97], s[96:97], vcc
  v_add_u32 v35, 8, v32
  v_cmp_gt_u32 s[98:99], s5, v35
  v_xor_b32 v36, s7, v77
  v_xor_b32 v38, s7, v79
  v_or_b32 v36, v36, v38
  v_cmp_ne_u32 vcc, 0, v36
  s_nop 3
  s_and_b64 vcc, vcc, s[98:99]
  s_or_b64 s[96:97], s[96:97], vcc
  v_add_u32 v35, 9, v32
  v_cmp_gt_u32 s[98:99], s5, v35
  v_xor_b32 v36, s7, v81
  v_xor_b32 v38, s7, v83
  v_or_b32 v36, v36, v38
  v_cmp_ne_u32 vcc, 0, v36
  s_nop 3
  s_and_b64 vcc, vcc, s[98:99]
  s_or_b64 s[96:97], s[96:97], vcc
  v_add_u32 v35, 10, v32
  v_cmp_gt_u32 s[98:99], s5, v35
  v_xor_b32 v36, s7, v85
  v_xor_b32 v38, s7, v87
  v_or_b32 v36, v36, v38
  v_cmp_ne_u32 vcc, 0, v36
  s_nop 3
  s_and_b64 vcc, vcc, s[98:99]
  s_or_b64 s[96:97], s[96:97], vcc
  s_add_u32 s11, s11, 1
  s_cmp_eq_u64 s[96:97], 0
  s_cbranch_scc1 L_pollEd
  s_cmp_lt_u32 s11, 0x8000
  s_cbranch_scc1 L_pollE
L_pollEd:
  v_mov_b32 v42, 0
  v_mov_b32 v43, 0
  v_add_u32 v35, 0, v32
  v_cmp_gt_u32 vcc, s5, v35
  s_nop 3
  s_mov_b64 exec, vcc
  v_fma_f32 v44, v240, v42, v44
  v_fma_f32 v46, v240, v43, v46
  v_fma_f32 v44, -v241, v43, v44
  v_fma_f32 v43, v241, v42, v46
  v_mov_b32 v42, v44
  s_mov_b64 exec, -1
  v_add_u32 v35, 1, v32
  v_cmp_gt_u32 vcc, s5, v35
  s_nop 3
  s_mov_b64 exec, vcc
  v_fma_f32 v48, v240, v42, v48
  v_fma_f32 v50, v240, v43, v50
  v_fma_f32 v48, -v241, v43, v48
  v_fma_f32 v43, v241, v42, v50
  v_mov_b32 v42, v48
  s_mov_b64 exec, -1
  v_add_u32 v35, 2, v32
  v_cmp_gt_u32 vcc, s5, v35
  s_nop 3
  s_mov_b64 exec, vcc
  v_fma_f32 v52, v240, v42, v52
  v_fma_f32 v54, v240, v43, v54
  v_fma_f32 v52, -v241, v43, v52
  v_fma_f32 v43, v241, v42, v54
  v_mov_b32 v42, v52
  s_mov_b64 exec, -1
  v_add_u32 v35, 3, v32
  v_cmp_gt_u32 vcc, s5, v35
  s_nop 3
  s_mov_b64 exec, vcc
  v_fma_f32 v56, v240, v42, v56
  v_fma_f32 v58, v240, v43, v58
  v_fma_f32 v56, -v241, v43, v56
  v_fma_f32 v43, v241, v42, v58
  v_mov_b32 v42, v56
  s_mov_b64 exec, -1
  v_add_u32 v35, 4, v32
  v_cmp_gt_u32 vcc, s5, v35
  s_nop 3
  s_mov_b64 exec, vcc
  v_fma_f32 v60, v240, v42, v60
  v_fma_f32 v62, v240, v43, v62
  v_fma_f32 v60, -v241, v43, v60
  v_fma_f32 v43, v241, v42, v62
  v_mov_b32 v42, v60
  s_mov_b64 exec, -1
  v_add_u32 v35, 5, v32
  v_cmp_gt_u32 vcc, s5, v35
  s_nop 3
  s_mov_b64 exec, vcc
  v_fma_f32 v64, v240, v42, v64
  v_fma_f32 v66, v240, v43, v66
  v_fma_f32 v64, -v241, v43, v64
  v_fma_f32 v43, v241, v42, v66
  v_mov_b32 v42, v64
  s_mov_b64 exec, -1
  v_add_u32 v35, 6, v32
  v_cmp_gt_u32 vcc, s5, v35
  s_nop 3
  s_mov_b64 exec, vcc
  v_fma_f32 v68, v240, v42, v68
  v_fma_f32 v70, v240, v43, v70
  v_fma_f32 v68, -v241, v43, v68
  v_fma_f32 v43, v241, v42, v70
  v_mov_b32 v42, v68
  s_mov_b64 exec, -1
  v_add_u32 v35, 7, v32
  v_cmp_gt_u32 vcc, s5, v35
  s_nop 3
  s_mov_b64 exec, vcc
  v_fma_f32 v72, v240, v42, v72
  v_fma_f32 v74, v240, v43, v74
  v_fma_f32 v72, -v241, v43, v72
  v_fma_f32 v43, v241, v42, v74
  v_mov_b32 v42, v72
  s_mov_b64 exec, -1
  v_add_u32 v35, 8, v32
  v_cmp_gt_u32 vcc, s5, v35
  s_nop 3
  s_mov_b64 exec, vcc
  v_fma_f32 v76, v240, v42, v76
  v_fma_f32 v78, v240, v43, v78
  v_fma_f32 v76, -v241, v43, v76
  v_fma_f32 v43, v241, v42, v78
  v_mov_b32 v42, v76
  s_mov_b64 exec, -1
  v_add_u32 v35, 9, v32
  v_cmp_gt_u32 vcc, s5, v35
  s_nop 3
  s_mov_b64 exec, vcc
  v_fma_f32 v80, v240, v42, v80
  v_fma_f32 v82, v240, v43, v82
  v_fma_f32 v80, -v241, v43, v80
  v_fma_f32 v43, v241, v42, v82
  v_mov_b32 v42, v80
  s_mov_b64 exec, -1
  v_add_u32 v35, 10, v32
  v_cmp_gt_u32 vcc, s5, v35
  s_nop 3
  s_mov_b64 exec, vcc
  v_fma_f32 v84, v240, v42, v84
  v_fma_f32 v86, v240, v43, v86
  v_fma_f32 v84, -v241, v43, v84
  v_fma_f32 v43, v241, v42, v86
  v_mov_b32 v42, v84
  s_mov_b64 exec, -1
  v_add_u32 v35, 11, v32
  v_sub_u32 v35, s5, v35
  v_max_i32 v35, 0, v35
  v_lshlrev_b32 v35, 6, v35
  v_cvt_f32_u32 v30, v35
  v_mul_f32 v28, v30, v242
  v_mul_f32 v29, v30, v243
  v_mul_f32 v28, 0x3fb8aa3b, v28
  v_mul_f32 v29, 0x3e22f983, v29
  v_exp_f32 v28, v28
  v_fract_f32 v29, v29
  v_cos_f32 v36, v29
  v_sin_f32 v37, v29
  v_mul_f32 v36, v36, v28
  v_mul_f32 v37, v37, v28
  v_mul_f32 v38, v36, v42
  v_fma_f32 v38, -v37, v43, v38
  v_mul_f32 v39, v36, v43
  v_fmac_f32 v39, v37, v42
  v_add_u32 v35, 20, v0
  v_lshlrev_b32 v35, 2, v35
  v_add_u32 v36, 80, v35
  ds_bpermute_b32 v40, v35, v38
  ds_bpermute_b32 v41, v35, v39
  ds_bpermute_b32 v42, v36, v38
  ds_bpermute_b32 v43, v36, v39
  s_waitcnt lgkmcnt(0)
  v_add_f32 v38, v38, v40
  v_add_f32 v39, v39, v41
  v_add_f32 v38, v38, v42
  v_add_f32 v39, v39, v43
  v_lshrrev_b32 v34, 3, v230
  v_and_b32 v33, 7, v230
  v_lshl_add_u32 v33, v34, 4, v33
  v_lshlrev_b32 v33, 2, v33
  v_add_u32 v33, 155648, v33
  s_mov_b64 exec, 0xfffff
  ds_write_b32 v33, v38 offset:768
  ds_write_b32 v33, v39 offset:800
  s_mov_b64 exec, -1
  s_waitcnt lgkmcnt(0)
  v_mov_b32 v33, 157064
  v_mov_b32 v34, 1
  s_mov_b64 exec, 1
  ds_add_u32 v33, v34
  s_mov_b64 exec, -1
  s_mul_i32 s8, s24, 24576
  s_add_u32 m0, s8, s35
  s_nop 0
  buffer_load_dwordx4 v21, s[68:71], s22 offen offset:0 lds
  buffer_load_dwordx4 v22, s[68:71], s22 offen offset:1024 lds
  buffer_load_dwordx4 v23, s[68:71], s22 offen offset:2048 lds
  buffer_load_dwordx4 v24, s[68:71], s22 offen offset:3072 lds
  s_add_u32 m0, m0, 4096
  s_nop 0
  buffer_load_dwordx4 v25, s[68:71], s22 offen offset:0 lds
  buffer_load_dwordx4 v26, s[68:71], s22 offen offset:1024 lds
  s_add_u32 s24, s24, 1
  s_cmp_eq_u32 s24, 3
  s_cselect_b32 s24, 0, s24
  s_add_u32 s23, s23, 1
  s_add_u32 s22, s22, 196608
  s_cmp_eq_u32 s23, 10
  s_cselect_b32 s8, 1966080, 0
  s_cselect_b32 s23, 0, s23
  s_sub_u32 s22, s22, s8
  s_mul_i32 s8, s24, 24576
  s_add_u32 m0, s8, s35
  s_nop 0
  buffer_load_dwordx4 v21, s[68:71], s22 offen offset:0 lds
  buffer_load_dwordx4 v22, s[68:71], s22 offen offset:1024 lds
  buffer_load_dwordx4 v23, s[68:71], s22 offen offset:2048 lds
  buffer_load_dwordx4 v24, s[68:71], s22 offen offset:3072 lds
  s_add_u32 m0, m0, 4096
  s_nop 0
  buffer_load_dwordx4 v25, s[68:71], s22 offen offset:0 lds
  buffer_load_dwordx4 v26, s[68:71], s22 offen offset:1024 lds
  s_add_u32 s24, s24, 1
  s_cmp_eq_u32 s24, 3
  s_cselect_b32 s24, 0, s24
  s_add_u32 s23, s23, 1
  s_add_u32 s22, s22, 196608
  s_cmp_eq_u32 s23, 10
  s_cselect_b32 s8, 1966080, 0
  s_cselect_b32 s23, 0, s23
  s_sub_u32 s22, s22, s8
  v_and_b32 v32, 31, v0
  v_lshrrev_b32 v33, 2, v32
  v_and_b32 v32, 3, v32
  v_lshlrev_b32 v32, 2, v32
  v_lshl_add_u32 v32, v33, 7, v32
  s_lshl_b32 s8, s5, 10
  v_add_u32 v32, s8, v32
  s_mov_b32 s10, 98304
  s_mov_b32 s11, 0
L_poll0:
  buffer_load_dword v33, v32, s[52:55], s10 offen sc1
  s_add_u32 s11, s11, 1
  s_waitcnt vmcnt(0)
  v_cmp_ne_u32 vcc, s7, v33
  s_nop 4
  s_cbranch_vccz L_polld0
  s_cmp_lt_u32 s11, 0x8000
  s_cbranch_scc1 L_poll0
L_polld0:
  s_cmp_eq_u32 s100, 1
  s_cbranch_scc1 L_noinv0
  buffer_inv sc1
  s_waitcnt vmcnt(0)
L_noinv0:
  s_mul_i32 s25, s13, 16384
  s_mul_i32 s8, s5, 81920
  s_add_u32 s25, s25, s8
  s_add_u32 s25, s25, 4194304
  s_mov_b32 s36, s13
  s_mov_b32 s37, 0
  s_add_u32 m0, s37, s92
  s_nop 0
  buffer_load_dwordx4 v10, s[52:55], s25 offen offset:0 sc1 lds
  buffer_load_dwordx4 v10, s[52:55], s25 offen offset:1024 sc1 lds
  buffer_load_dwordx4 v10, s[52:55], s25 offen offset:2048 sc1 lds
  buffer_load_dwordx4 v10, s[52:55], s25 offen offset:3072 sc1 lds
  s_add_u32 s36, s36, 1
  s_add_u32 s25, s25, 16384
  s_cmp_eq_u32 s36, 5
  s_cselect_b32 s8, 81920, 0
  s_cselect_b32 s36, 0, s36
  s_sub_u32 s25, s25, s8
  s_add_u32 s37, s37, 16384
  s_cmp_eq_u32 s37, 81920
  s_cselect_b32 s37, 0, s37
  s_add_u32 m0, s37, s92
  s_nop 0
  buffer_load_dwordx4 v10, s[52:55], s25 offen offset:0 sc1 lds
  buffer_load_dwordx4 v10, s[52:55], s25 offen offset:1024 sc1 lds
  buffer_load_dwordx4 v10, s[52:55], s25 offen offset:2048 sc1 lds
  buffer_load_dwordx4 v10, s[52:55], s25 offen offset:3072 sc1 lds
  s_add_u32 s36, s36, 1
  s_add_u32 s25, s25, 16384
  s_cmp_eq_u32 s36, 5
  s_cselect_b32 s8, 81920, 0
  s_cselect_b32 s36, 0, s36
  s_sub_u32 s25, s25, s8
  s_add_u32 s37, s37, 16384
  s_cmp_eq_u32 s37, 81920
  s_cselect_b32 s37, 0, s37
  s_waitcnt vmcnt(4)
  s_barrier
  s_add_u32 m0, s37, s92
  s_nop 0
  buffer_load_dwordx4 v10, s[52:55], s25 offen offset:0 sc1 lds
  buffer_load_dwordx4 v10, s[52:55], s25 offen offset:1024 sc1 lds
  buffer_load_dwordx4 v10, s[52:55], s25 offen offset:2048 sc1 lds
  buffer_load_dwordx4 v10, s[52:55], s25 offen offset:3072 sc1 lds
  s_add_u32 s36, s36, 1
  s_add_u32 s25, s25, 16384
  s_cmp_eq_u32 s36, 5
  s_cselect_b32 s8, 81920, 0
  s_cselect_b32 s36, 0, s36
  s_sub_u32 s25, s25, s8
  s_add_u32 s37, s37, 16384
  s_cmp_eq_u32 s37, 81920
  s_cselect_b32 s37, 0, s37
  s_add_u32 m0, s37, s92
  s_nop 0
  buffer_load_dwordx4 v10, s[52:55], s25 offen offset:0 sc1 lds
  buffer_load_dwordx4 v10, s[52:55], s25 offen offset:1024 sc1 lds
  buffer_load_dwordx4 v10, s[52:55], s25 offen offset:2048 sc1 lds
  buffer_load_dwordx4 v10, s[52:55], s25 offen offset:3072 sc1 lds
  s_add_u32 s36, s36, 1
  s_add_u32 s25, s25, 16384
  s_cmp_eq_u32 s36, 5
  s_cselect_b32 s8, 81920, 0
  s_cselect_b32 s36, 0, s36
  s_sub_u32 s25, s25, s8
  s_add_u32 s37, s37, 16384
  s_cmp_eq_u32 s37, 81920
  s_cselect_b32 s37, 0, s37
  s_add_u32 m0, s37, s92
  s_nop 0
  buffer_load_dwordx4 v10, s[52:55], s25 offen offset:0 sc1 lds
  buffer_load_dwordx4 v10, s[52:55], s25 offen offset:1024 sc1 lds
  buffer_load_dwordx4 v10, s[52:55], s25 offen offset:2048 sc1 lds
  buffer_load_dwordx4 v10, s[52:55], s25 offen offset:3072 sc1 lds
  s_add_u32 s36, s36, 1
  s_add_u32 s25, s25, 16384
  s_cmp_eq_u32 s36, 5
  s_cselect_b32 s8, 81920, 0
  s_cselect_b32 s36, 0, s36
  s_sub_u32 s25, s25, s8
  s_add_u32 s37, s37, 16384
  s_cmp_eq_u32 s37, 81920
  s_cselect_b32 s37, 0, s37
  s_barrier
  s_mul_i32 s8, s24, 24576
  s_add_u32 m0, s8, s35
  s_nop 0
  buffer_load_dwordx4 v21, s[68:71], s22 offen offset:0 lds
  buffer_load_dwordx4 v22, s[68:71], s22 offen offset:1024 lds
  buffer_load_dwordx4 v23, s[68:71], s22 offen offset:2048 lds
  buffer_load_dwordx4 v24, s[68:71], s22 offen offset:3072 lds
  s_add_u32 m0, m0, 4096
  s_nop 0
  buffer_load_dwordx4 v25, s[68:71], s22 offen offset:0 lds
  buffer_load_dwordx4 v26, s[68:71], s22 offen offset:1024 lds
  s_add_u32 s24, s24, 1
  s_cmp_eq_u32 s24, 3
  s_cselect_b32 s24, 0, s24
  s_add_u32 s23, s23, 1
  s_add_u32 s22, s22, 196608
  s_cmp_eq_u32 s23, 10
  s_cselect_b32 s8, 1966080, 0
  s_cselect_b32 s23, 0, s23
  s_sub_u32 s22, s22, s8
  s_waitcnt vmcnt(18)
  s_barrier
  s_mul_i32 s8, s24, 24576
  s_add_u32 m0, s8, s35
  s_nop 0
  buffer_load_dwordx4 v21, s[68:71], s22 offen offset:0 lds
  buffer_load_dwordx4 v22, s[68:71], s22 offen offset:1024 lds
  buffer_load_dwordx4 v23, s[68:71], s22 offen offset:2048 lds
  buffer_load_dwordx4 v24, s[68:71], s22 offen offset:3072 lds
  s_add_u32 m0, m0, 4096
  s_nop 0
  buffer_load_dwordx4 v25, s[68:71], s22 offen offset:0 lds
  buffer_load_dwordx4 v26, s[68:71], s22 offen offset:1024 lds
  s_add_u32 s24, s24, 1
  s_cmp_eq_u32 s24, 3
  s_cselect_b32 s24, 0, s24
  s_add_u32 s23, s23, 1
  s_add_u32 s22, s22, 196608
  s_cmp_eq_u32 s23, 10
  s_cselect_b32 s8, 1966080, 0
  s_cselect_b32 s23, 0, s23
  s_sub_u32 s22, s22, s8
  s_mov_b32 s101, 5
L_ll_g23:
  s_waitcnt vmcnt(6)
  s_barrier
  s_mul_i32 s8, s24, 24576
  s_add_u32 m0, s8, s35
  s_nop 0
  buffer_load_dwordx4 v21, s[68:71], s22 offen offset:0 lds
  buffer_load_dwordx4 v22, s[68:71], s22 offen offset:1024 lds
  buffer_load_dwordx4 v23, s[68:71], s22 offen offset:2048 lds
  buffer_load_dwordx4 v24, s[68:71], s22 offen offset:3072 lds
  s_add_u32 m0, m0, 4096
  s_nop 0
  buffer_load_dwordx4 v25, s[68:71], s22 offen offset:0 lds
  buffer_load_dwordx4 v26, s[68:71], s22 offen offset:1024 lds
  s_add_u32 s24, s24, 1
  s_cmp_eq_u32 s24, 3
  s_cselect_b32 s24, 0, s24
  s_add_u32 s23, s23, 1
  s_add_u32 s22, s22, 196608
  s_cmp_eq_u32 s23, 10
  s_cselect_b32 s8, 1966080, 0
  s_cselect_b32 s23, 0, s23
  s_sub_u32 s22, s22, s8
  s_sub_u32 s101, s101, 1
  s_cmp_lg_u32 s101, 0
  s_cbranch_scc1 L_ll_g23
  s_waitcnt vmcnt(6)
  s_barrier
  v_and_b32 v93, 31, v0
  v_lshrrev_b32 v33, 2, v93
  v_and_b32 v93, 3, v93
  v_lshlrev_b32 v93, 2, v93
  v_lshl_add_u32 v93, v33, 7, v93
  s_lshl_b32 s8, s5, 10
  v_add_u32 v93, s8, v93
  s_mov_b32 s10, 131072
  buffer_load_dword v92, v93, s[52:55], s10 offen sc1
  s_mov_b32 s23, s38
  s_cmp_ge_u32 s23, 5
  s_cselect_b32 s8, 5, 0
  s_sub_u32 s8, s23, s8
  s_lshl_b32 s8, s8, 8
  s_add_u32 s22, s8, s90
  s_cmp_ge_u32 s23, 5
  s_cselect_b32 s84, s28, s26
  s_cselect_b32 s85, s33, s32
  s_mul_i32 s8, s24, 20480
  s_add_u32 m0, s8, s34
  s_nop 0
  buffer_load_dwordx4 v16, s[84:87], s22 offen offset:0 lds
  buffer_load_dwordx4 v17, s[84:87], s22 offen offset:1024 lds
  buffer_load_dwordx4 v18, s[84:87], s22 offen offset:2048 lds
  buffer_load_dwordx4 v19, s[84:87], s22 offen offset:3072 lds
  s_add_u32 m0, m0, 4096
  s_nop 0
  buffer_load_dwordx4 v20, s[84:87], s22 offen offset:0 lds
  s_add_u32 s24, s24, 1
  s_cmp_eq_u32 s24, 3
  s_cselect_b32 s24, 0, s24
  s_add_u32 s23, s23, 1
  s_add_u32 s22, s22, 256
  s_cmp_eq_u32 s23, 5
  s_cselect_b32 s22, s90, s22
  s_cmp_eq_u32 s23, 10
  s_cselect_b32 s22, s90, s22
  s_cselect_b32 s23, 0, s23
  s_waitcnt vmcnt(6)
  s_barrier
  s_cmp_ge_u32 s23, 5
  s_cselect_b32 s84, s28, s26
  s_cselect_b32 s85, s33, s32
  s_mul_i32 s8, s24, 20480
  s_add_u32 m0, s8, s34
  s_nop 0
  buffer_load_dwordx4 v16, s[84:87], s22 offen offset:0 lds
  buffer_load_dwordx4 v17, s[84:87], s22 offen offset:1024 lds
  buffer_load_dwordx4 v18, s[84:87], s22 offen offset:2048 lds
  buffer_load_dwordx4 v19, s[84:87], s22 offen offset:3072 lds
  s_add_u32 m0, m0, 4096
  s_nop 0
  buffer_load_dwordx4 v20, s[84:87], s22 offen offset:0 lds
  s_add_u32 s24, s24, 1
  s_cmp_eq_u32 s24, 3
  s_cselect_b32 s24, 0, s24
  s_add_u32 s23, s23, 1
  s_add_u32 s22, s22, 256
  s_cmp_eq_u32 s23, 5
  s_cselect_b32 s22, s90, s22
  s_cmp_eq_u32 s23, 10
  s_cselect_b32 s22, s90, s22
  s_cselect_b32 s23, 0, s23
  s_barrier
  s_cmp_ge_u32 s23, 5
  s_cselect_b32 s84, s28, s26
  s_cselect_b32 s85, s33, s32
  s_mul_i32 s8, s24, 20480
  s_add_u32 m0, s8, s34
  s_nop 0
  buffer_load_dwordx4 v16, s[84:87], s22 offen offset:0 lds
  buffer_load_dwordx4 v17, s[84:87], s22 offen offset:1024 lds
  buffer_load_dwordx4 v18, s[84:87], s22 offen offset:2048 lds
  buffer_load_dwordx4 v19, s[84:87], s22 offen offset:3072 lds
  s_add_u32 m0, m0, 4096
  s_nop 0
  buffer_load_dwordx4 v20, s[84:87], s22 offen offset:0 lds
  s_add_u32 s24, s24, 1
  s_cmp_eq_u32 s24, 3
  s_cselect_b32 s24, 0, s24
  s_add_u32 s23, s23, 1
  s_add_u32 s22, s22, 256
  s_cmp_eq_u32 s23, 5
  s_cselect_b32 s22, s90, s22
  s_cmp_eq_u32 s23, 10
  s_cselect_b32 s22, s90, s22
  s_cselect_b32 s23, 0, s23
  s_waitcnt vmcnt(15)
  v_cmp_ne_u32 vcc, s7, v92
  s_nop 4
  s_cbranch_vccz L_fc_ok_FH
  s_mov_b32 s10, 131072
  s_mov_b32 s11, 0
L_fc_FH:
  buffer_load_dword v92, v93, s[52:55], s10 offen sc1
  s_add_u32 s11, s11, 1
  s_waitcnt vmcnt(0)
  v_cmp_ne_u32 vcc, s7, v92
  s_nop 4
  s_cbranch_vccz L_fc_ok_FH
  s_cmp_lt_u32 s11, 0x8000
  s_cbranch_scc1 L_fc_FH
L_fc_ok_FH:
  s_cmp_eq_u32 s100, 1
  s_cbranch_scc1 L_fc_ni_FH
  buffer_inv sc1
  s_waitcnt vmcnt(0)
L_fc_ni_FH:
  s_mul_i32 s25, s38, 16384
  s_mul_i32 s8, s5, 163840
  s_add_u32 s25, s25, s8
  s_add_u32 s25, s25, 7340032
  s_mov_b32 s36, s38
  s_mov_b32 s37, 0
  s_add_u32 m0, s37, s92
  s_nop 0
  buffer_load_dwordx4 v10, s[52:55], s25 offen offset:0 sc1 lds
  buffer_load_dwordx4 v10, s[52:55], s25 offen offset:1024 sc1 lds
  buffer_load_dwordx4 v10, s[52:55], s25 offen offset:2048 sc1 lds
  buffer_load_dwordx4 v10, s[52:55], s25 offen offset:3072 sc1 lds
  s_add_u32 s36, s36, 1
  s_add_u32 s25, s25, 16384
  s_cmp_eq_u32 s36, 10
  s_cselect_b32 s8, 163840, 0
  s_cselect_b32 s36, 0, s36
  s_sub_u32 s25, s25, s8
  s_add_u32 s37, s37, 16384
  s_cmp_eq_u32 s37, 81920
  s_cselect_b32 s37, 0, s37
  s_add_u32 m0, s37, s92
  s_nop 0
  buffer_load_dwordx4 v10, s[52:55], s25 offen offset:0 sc1 lds
  buffer_load_dwordx4 v10, s[52:55], s25 offen offset:1024 sc1 lds
  buffer_load_dwordx4 v10, s[52:55], s25 offen offset:2048 sc1 lds
  buffer_load_dwordx4 v10, s[52:55], s25 offen offset:3072 sc1 lds
  s_add_u32 s36, s36, 1
  s_add_u32 s25, s25, 16384
  s_cmp_eq_u32 s36, 10
  s_cselect_b32 s8, 163840, 0
  s_cselect_b32 s36, 0, s36
  s_sub_u32 s25, s25, s8
  s_add_u32 s37, s37, 16384
  s_cmp_eq_u32 s37, 81920
  s_cselect_b32 s37, 0, s37
  s_add_u32 m0, s37, s92
  s_nop 0
  buffer_load_dwordx4 v10, s[52:55], s25 offen offset:0 sc1 lds
  buffer_load_dwordx4 v10, s[52:55], s25 offen offset:1024 sc1 lds
  buffer_load_dwordx4 v10, s[52:55], s25 offen offset:2048 sc1 lds
  buffer_load_dwordx4 v10, s[52:55], s25 offen offset:3072 sc1 lds
  s_add_u32 s36, s36, 1
  s_add_u32 s25, s25, 16384
  s_cmp_eq_u32 s36, 10
  s_cselect_b32 s8, 163840, 0
  s_cselect_b32 s36, 0, s36
  s_sub_u32 s25, s25, s8
  s_add_u32 s37, s37, 16384
  s_cmp_eq_u32 s37, 81920
  s_cselect_b32 s37, 0, s37
  s_waitcnt vmcnt(8)
  s_barrier
  s_add_u32 m0, s37, s92
  s_nop 0
  buffer_load_dwordx4 v10, s[52:55], s25 offen offset:0 sc1 lds
  buffer_load_dwordx4 v10, s[52:55], s25 offen offset:1024 sc1 lds
  buffer_load_dwordx4 v10, s[52:55], s25 offen offset:2048 sc1 lds
  buffer_load_dwordx4 v10, s[52:55], s25 offen offset:3072 sc1 lds
  s_add_u32 s36, s36, 1
  s_add_u32 s25, s25, 16384
  s_cmp_eq_u32 s36, 10
  s_cselect_b32 s8, 163840, 0
  s_cselect_b32 s36, 0, s36
  s_sub_u32 s25, s25, s8
  s_add_u32 s37, s37, 16384
  s_cmp_eq_u32 s37, 81920
  s_cselect_b32 s37, 0, s37
  s_add_u32 m0, s37, s92
  s_nop 0
  buffer_load_dwordx4 v10, s[52:55], s25 offen offset:0 sc1 lds
  buffer_load_dwordx4 v10, s[52:55], s25 offen offset:1024 sc1 lds
  buffer_load_dwordx4 v10, s[52:55], s25 offen offset:2048 sc1 lds
  buffer_load_dwordx4 v10, s[52:55], s25 offen offset:3072 sc1 lds
  s_add_u32 s36, s36, 1
  s_add_u32 s25, s25, 16384
  s_cmp_eq_u32 s36, 10
  s_cselect_b32 s8, 163840, 0
  s_cselect_b32 s36, 0, s36
  s_sub_u32 s25, s25, s8
  s_add_u32 s37, s37, 16384
  s_cmp_eq_u32 s37, 81920
  s_cselect_b32 s37, 0, s37
  s_waitcnt vmcnt(12)
  s_barrier
  s_add_u32 m0, s37, s92
  s_nop 0
  buffer_load_dwordx4 v10, s[52:55], s25 offen offset:0 sc1 lds
  buffer_load_dwordx4 v10, s[52:55], s25 offen offset:1024 sc1 lds
  buffer_load_dwordx4 v10, s[52:55], s25 offen offset:2048 sc1 lds
  buffer_load_dwordx4 v10, s[52:55], s25 offen offset:3072 sc1 lds
  s_add_u32 s36, s36, 1
  s_add_u32 s25, s25, 16384
  s_cmp_eq_u32 s36, 10
  s_cselect_b32 s8, 163840, 0
  s_cselect_b32 s36, 0, s36
  s_sub_u32 s25, s25, s8
  s_add_u32 s37, s37, 16384
  s_cmp_eq_u32 s37, 81920
  s_cselect_b32 s37, 0, s37
  s_cmp_ge_u32 s23, 5
  s_cselect_b32 s84, s28, s26
  s_cselect_b32 s85, s33, s32
  s_mul_i32 s8, s24, 20480
  s_add_u32 m0, s8, s34
  s_nop 0
  buffer_load_dwordx4 v16, s[84:87], s22 offen offset:0 lds
  buffer_load_dwordx4 v17, s[84:87], s22 offen offset:1024 lds
  buffer_load_dwordx4 v18, s[84:87], s22 offen offset:2048 lds
  buffer_load_dwordx4 v19, s[84:87], s22 offen offset:3072 lds
  s_add_u32 m0, m0, 4096
  s_nop 0
  buffer_load_dwordx4 v20, s[84:87], s22 offen offset:0 lds
  s_add_u32 s24, s24, 1
  s_cmp_eq_u32 s24, 3
  s_cselect_b32 s24, 0, s24
  s_add_u32 s23, s23, 1
  s_add_u32 s22, s22, 256
  s_cmp_eq_u32 s23, 5
  s_cselect_b32 s22, s90, s22
  s_cmp_eq_u32 s23, 10
  s_cselect_b32 s22, s90, s22
  s_cselect_b32 s23, 0, s23
  s_waitcnt vmcnt(17)
  s_barrier
  s_add_u32 m0, s37, s92
  s_nop 0
  buffer_load_dwordx4 v10, s[52:55], s25 offen offset:0 sc1 lds
  buffer_load_dwordx4 v10, s[52:55], s25 offen offset:1024 sc1 lds
  buffer_load_dwordx4 v10, s[52:55], s25 offen offset:2048 sc1 lds
  buffer_load_dwordx4 v10, s[52:55], s25 offen offset:3072 sc1 lds
  s_add_u32 s36, s36, 1
  s_add_u32 s25, s25, 16384
  s_cmp_eq_u32 s36, 10
  s_cselect_b32 s8, 163840, 0
  s_cselect_b32 s36, 0, s36
  s_sub_u32 s25, s25, s8
  s_add_u32 s37, s37, 16384
  s_cmp_eq_u32 s37, 81920
  s_cselect_b32 s37, 0, s37
  s_cmp_ge_u32 s23, 5
  s_cselect_b32 s84, s28, s26
  s_cselect_b32 s85, s33, s32
  s_mul_i32 s8, s24, 20480
  s_add_u32 m0, s8, s34
  s_nop 0
  buffer_load_dwordx4 v16, s[84:87], s22 offen offset:0 lds
  buffer_load_dwordx4 v17, s[84:87], s22 offen offset:1024 lds
  buffer_load_dwordx4 v18, s[84:87], s22 offen offset:2048 lds
  buffer_load_dwordx4 v19, s[84:87], s22 offen offset:3072 lds
  s_add_u32 m0, m0, 4096
  s_nop 0
  buffer_load_dwordx4 v20, s[84:87], s22 offen offset:0 lds
  s_add_u32 s24, s24, 1
  s_cmp_eq_u32 s24, 3
  s_cselect_b32 s24, 0, s24
  s_add_u32 s23, s23, 1
  s_add_u32 s22, s22, 256
  s_cmp_eq_u32 s23, 5
  s_cselect_b32 s22, s90, s22
  s_cmp_eq_u32 s23, 10
  s_cselect_b32 s22, s90, s22
  s_cselect_b32 s23, 0, s23
  s_waitcnt vmcnt(9)
  s_barrier
  s_add_u32 m0, s37, s92
  s_nop 0
  buffer_load_dwordx4 v10, s[52:55], s25 offen offset:0 sc1 lds
  buffer_load_dwordx4 v10, s[52:55], s25 offen offset:1024 sc1 lds
  buffer_load_dwordx4 v10, s[52:55], s25 offen offset:2048 sc1 lds
  buffer_load_dwordx4 v10, s[52:55], s25 offen offset:3072 sc1 lds
  s_add_u32 s36, s36, 1
  s_add_u32 s25, s25, 16384
  s_cmp_eq_u32 s36, 10
  s_cselect_b32 s8, 163840, 0
  s_cselect_b32 s36, 0, s36
  s_sub_u32 s25, s25, s8
  s_add_u32 s37, s37, 16384
  s_cmp_eq_u32 s37, 81920
  s_cselect_b32 s37, 0, s37
  s_cmp_ge_u32 s23, 5
  s_cselect_b32 s84, s28, s26
  s_cselect_b32 s85, s33, s32
  s_mul_i32 s8, s24, 20480
  s_add_u32 m0, s8, s34
  s_nop 0
  buffer_load_dwordx4 v16, s[84:87], s22 offen offset:0 lds
  buffer_load_dwordx4 v17, s[84:87], s22 offen offset:1024 lds
  buffer_load_dwordx4 v18, s[84:87], s22 offen offset:2048 lds
  buffer_load_dwordx4 v19, s[84:87], s22 offen offset:3072 lds
  s_add_u32 m0, m0, 4096
  s_nop 0
  buffer_load_dwordx4 v20, s[84:87], s22 offen offset:0 lds
  s_add_u32 s24, s24, 1
  s_cmp_eq_u32 s24, 3
  s_cselect_b32 s24, 0, s24
  s_add_u32 s23, s23, 1
  s_add_u32 s22, s22, 256
  s_cmp_eq_u32 s23, 5
  s_cselect_b32 s22, s90, s22
  s_cmp_eq_u32 s23, 10
  s_cselect_b32 s22, s90, s22
  s_cselect_b32 s23, 0, s23
  s_waitcnt vmcnt(9)
  s_barrier
  s_add_u32 m0, s37, s92
  s_nop 0
  buffer_load_dwordx4 v10, s[52:55], s25 offen offset:0 sc1 lds
  buffer_load_dwordx4 v10, s[52:55], s25 offen offset:1024 sc1 lds
  buffer_load_dwordx4 v10, s[52:55], s25 offen offset:2048 sc1 lds
  buffer_load_dwordx4 v10, s[52:55], s25 offen offset:3072 sc1 lds
  s_add_u32 s36, s36, 1
  s_add_u32 s25, s25, 16384
  s_cmp_eq_u32 s36, 10
  s_cselect_b32 s8, 163840, 0
  s_cselect_b32 s36, 0, s36
  s_sub_u32 s25, s25, s8
  s_add_u32 s37, s37, 16384
  s_cmp_eq_u32 s37, 81920
  s_cselect_b32 s37, 0, s37
  s_cmp_ge_u32 s23, 5
  s_cselect_b32 s84, s28, s26
  s_cselect_b32 s85, s33, s32
  s_mul_i32 s8, s24, 20480
  s_add_u32 m0, s8, s34
  s_nop 0
  buffer_load_dwordx4 v16, s[84:87], s22 offen offset:0 lds
  buffer_load_dwordx4 v17, s[84:87], s22 offen offset:1024 lds
  buffer_load_dwordx4 v18, s[84:87], s22 offen offset:2048 lds
  buffer_load_dwordx4 v19, s[84:87], s22 offen offset:3072 lds
  s_add_u32 m0, m0, 4096
  s_nop 0
  buffer_load_dwordx4 v20, s[84:87], s22 offen offset:0 lds
  s_add_u32 s24, s24, 1
  s_cmp_eq_u32 s24, 3
  s_cselect_b32 s24, 0, s24
  s_add_u32 s23, s23, 1
  s_add_u32 s22, s22, 256
  s_cmp_eq_u32 s23, 5
  s_cselect_b32 s22, s90, s22
  s_cmp_eq_u32 s23, 10
  s_cselect_b32 s22, s90, s22
  s_cselect_b32 s23, 0, s23
  s_waitcnt vmcnt(9)
  s_barrier
  v_and_b32 v93, 31, v0
  v_lshrrev_b32 v33, 2, v93
  v_and_b32 v93, 3, v93
  v_lshlrev_b32 v93, 2, v93
  v_lshl_add_u32 v93, v33, 7, v93
  s_lshl_b32 s8, s5, 10
  v_add_u32 v93, s8, v93
  s_mov_b32 s10, 163840
  buffer_load_dword v92, v93, s[52:55], s10 offen sc1
  s_add_u32 m0, s37, s92
  s_nop 0
  buffer_load_dwordx4 v10, s[52:55], s25 offen offset:0 sc1 lds
  buffer_load_dwordx4 v10, s[52:55], s25 offen offset:1024 sc1 lds
  buffer_load_dwordx4 v10, s[52:55], s25 offen offset:2048 sc1 lds
  buffer_load_dwordx4 v10, s[52:55], s25 offen offset:3072 sc1 lds
  s_add_u32 s36, s36, 1
  s_add_u32 s25, s25, 16384
  s_cmp_eq_u32 s36, 10
  s_cselect_b32 s8, 163840, 0
  s_cselect_b32 s36, 0, s36
  s_sub_u32 s25, s25, s8
  s_add_u32 s37, s37, 16384
  s_cmp_eq_u32 s37, 81920
  s_cselect_b32 s37, 0, s37
  s_cmp_ge_u32 s23, 5
  s_cselect_b32 s84, s28, s26
  s_cselect_b32 s85, s33, s32
  s_mul_i32 s8, s24, 20480
  s_add_u32 m0, s8, s34
  s_nop 0
  buffer_load_dwordx4 v16, s[84:87], s22 offen offset:0 lds
  buffer_load_dwordx4 v17, s[84:87], s22 offen offset:1024 lds
  buffer_load_dwordx4 v18, s[84:87], s22 offen offset:2048 lds
  buffer_load_dwordx4 v19, s[84:87], s22 offen offset:3072 lds
  s_add_u32 m0, m0, 4096
  s_nop 0
  buffer_load_dwordx4 v20, s[84:87], s22 offen offset:0 lds
  s_add_u32 s24, s24, 1
  s_cmp_eq_u32 s24, 3
  s_cselect_b32 s24, 0, s24
  s_add_u32 s23, s23, 1
  s_add_u32 s22, s22, 256
  s_cmp_eq_u32 s23, 5
  s_cselect_b32 s22, s90, s22
  s_cmp_eq_u32 s23, 10
  s_cselect_b32 s22, s90, s22
  s_cselect_b32 s23, 0, s23
  s_waitcnt vmcnt(10)
  s_barrier
  v_min_u32 v95, 47, v0
  v_lshlrev_b32 v95, 2, v95
  s_lshl_b32 s8, s4, 8
  v_add_u32 v95, s8, v95
  s_mov_b32 s10, 229376
  buffer_load_dword v94, v95, s[52:55], s10 offen sc1
  s_mul_i32 s8, s51, 5120
  v_lshlrev_b32 v122, 4, v0
  v_add_u32 v122, s8, v122
  v_add_u32 v123, 4096, v122
  s_cmp_ge_u32 s23, 5
  s_cselect_b32 s84, s28, s26
  s_cselect_b32 s85, s33, s32
  s_mul_i32 s8, s24, 20480
  s_add_u32 m0, s8, s34
  s_nop 0
  buffer_load_dwordx4 v16, s[84:87], s22 offen offset:0 lds
  buffer_load_dwordx4 v17, s[84:87], s22 offen offset:1024 lds
  buffer_load_dwordx4 v18, s[84:87], s22 offen offset:2048 lds
  buffer_load_dwordx4 v19, s[84:87], s22 offen offset:3072 lds
  s_add_u32 m0, m0, 4096
  s_nop 0
  buffer_load_dwordx4 v20, s[84:87], s22 offen offset:0 lds
  s_add_u32 s24, s24, 1
  s_cmp_eq_u32 s24, 3
  s_cselect_b32 s24, 0, s24
  s_add_u32 s23, s23, 1
  s_add_u32 s22, s22, 256
  s_cmp_eq_u32 s23, 5
  s_cselect_b32 s22, s90, s22
  s_cmp_eq_u32 s23, 10
  s_cselect_b32 s22, s90, s22
  s_cselect_b32 s23, 0, s23
  s_waitcnt vmcnt(6)
  s_barrier
  s_cmp_ge_u32 s23, 5
  s_cselect_b32 s84, s28, s26
  s_cselect_b32 s85, s33, s32
  s_mul_i32 s8, s24, 20480
  s_add_u32 m0, s8, s34
  s_nop 0
  buffer_load_dwordx4 v16, s[84:87], s22 offen offset:0 lds
  buffer_load_dwordx4 v17, s[84:87], s22 offen offset:1024 lds
  buffer_load_dwordx4 v18, s[84:87], s22 offen offset:2048 lds
  buffer_load_dwordx4 v19, s[84:87], s22 offen offset:3072 lds
  s_add_u32 m0, m0, 4096
  s_nop 0
  buffer_load_dwordx4 v20, s[84:87], s22 offen offset:0 lds
  s_add_u32 s24, s24, 1
  s_cmp_eq_u32 s24, 3
  s_cselect_b32 s24, 0, s24
  s_add_u32 s23, s23, 1
  s_add_u32 s22, s22, 256
  s_cmp_eq_u32 s23, 5
  s_cselect_b32 s22, s90, s22
  s_cmp_eq_u32 s23, 10
  s_cselect_b32 s22, s90, s22
  s_cselect_b32 s23, 0, s23
  v_cmp_ne_u32 vcc, s7, v92
  s_nop 4
  s_cbranch_vccz L_fc_ok_F3
  s_mov_b32 s10, 163840
  s_mov_b32 s11, 0
L_fc_F3:
  buffer_load_dword v92, v93, s[52:55], s10 offen sc1
  s_add_u32 s11, s11, 1
  s_waitcnt vmcnt(0)
  v_cmp_ne_u32 vcc, s7, v92
  s_nop 4
  s_cbranch_vccz L_fc_ok_F3
  s_cmp_lt_u32 s11, 0x8000
  s_cbranch_scc1 L_fc_F3
L_fc_ok_F3:
  s_cmp_eq_u32 s100, 1
  s_cbranch_scc1 L_fc_ni_F3
  buffer_inv sc1
  s_waitcnt vmcnt(0)
L_fc_ni_F3:
  s_mul_i32 s25, s39, 16384
  s_mul_i32 s8, s5, 196608
  s_add_u32 s25, s25, s8
  s_add_u32 s25, s25, 13631488
  s_mov_b32 s36, s39
  s_add_u32 m0, s37, s92
  s_nop 0
  buffer_load_dwordx4 v10, s[52:55], s25 offen offset:0 sc1 lds
  buffer_load_dwordx4 v10, s[52:55], s25 offen offset:1024 sc1 lds
  buffer_load_dwordx4 v10, s[52:55], s25 offen offset:2048 sc1 lds
  buffer_load_dwordx4 v10, s[52:55], s25 offen offset:3072 sc1 lds
  s_add_u32 s36, s36, 1
  s_add_u32 s25, s25, 16384
  s_cmp_eq_u32 s36, 12
  s_cselect_b32 s8, 196608, 0
  s_cselect_b32 s36, 0, s36
  s_sub_u32 s25, s25, s8
  s_add_u32 s37, s37, 16384
  s_cmp_eq_u32 s37, 81920
  s_cselect_b32 s37, 0, s37
  s_add_u32 m0, s37, s92
  s_nop 0
  buffer_load_dwordx4 v10, s[52:55], s25 offen offset:0 sc1 lds
  buffer_load_dwordx4 v10, s[52:55], s25 offen offset:1024 sc1 lds
  buffer_load_dwordx4 v10, s[52:55], s25 offen offset:2048 sc1 lds
  buffer_load_dwordx4 v10, s[52:55], s25 offen offset:3072 sc1 lds
  s_add_u32 s36, s36, 1
  s_add_u32 s25, s25, 16384
  s_cmp_eq_u32 s36, 12
  s_cselect_b32 s8, 196608, 0
  s_cselect_b32 s36, 0, s36
  s_sub_u32 s25, s25, s8
  s_add_u32 s37, s37, 16384
  s_cmp_eq_u32 s37, 81920
  s_cselect_b32 s37, 0, s37
  s_waitcnt vmcnt(13)
  s_barrier
  v_cmp_ne_u32 vcc, s7, v94
  s_nop 4
  s_cbranch_vccz L_fc_ok_FW
  s_mov_b32 s10, 229376
  s_mov_b32 s11, 0
L_fc_FW:
  buffer_load_dword v94, v95, s[52:55], s10 offen sc1
  s_add_u32 s11, s11, 1
  s_waitcnt vmcnt(0)
  v_cmp_ne_u32 vcc, s7, v94
  s_nop 4
  s_cbranch_vccz L_fc_ok_FW
  s_cmp_lt_u32 s11, 0x8000
  s_cbranch_scc1 L_fc_FW
L_fc_ok_FW:
  s_mov_b32 s23, s39
  s_mul_i32 s22, s23, 20480
  s_mul_i32 s8, s4, 245760
  s_add_u32 s22, s22, s8
  s_add_u32 s22, s22, 20971520
  s_add_u32 m0, s37, s92
  s_nop 0
  buffer_load_dwordx4 v10, s[52:55], s25 offen offset:0 sc1 lds
  buffer_load_dwordx4 v10, s[52:55], s25 offen offset:1024 sc1 lds
  buffer_load_dwordx4 v10, s[52:55], s25 offen offset:2048 sc1 lds
  buffer_load_dwordx4 v10, s[52:55], s25 offen offset:3072 sc1 lds
  s_add_u32 s36, s36, 1
  s_add_u32 s25, s25, 16384
  s_cmp_eq_u32 s36, 12
  s_cselect_b32 s8, 196608, 0
  s_cselect_b32 s36, 0, s36
  s_sub_u32 s25, s25, s8
  s_add_u32 s37, s37, 16384
  s_cmp_eq_u32 s37, 81920
  s_cselect_b32 s37, 0, s37
  s_mul_i32 s8, s24, 20480
  s_add_u32 m0, s8, s34
  s_nop 0
  buffer_load_dwordx4 v122, s[52:55], s22 offen offset:0 sc1 lds
  buffer_load_dwordx4 v122, s[52:55], s22 offen offset:1024 sc1 lds
  buffer_load_dwordx4 v122, s[52:55], s22 offen offset:2048 sc1 lds
  buffer_load_dwordx4 v122, s[52:55], s22 offen offset:3072 sc1 lds
  s_add_u32 m0, m0, 4096
  s_nop 0
  buffer_load_dwordx4 v123, s[52:55], s22 offen sc1 lds
  s_add_u32 s24, s24, 1
  s_cmp_eq_u32 s24, 3
  s_cselect_b32 s24, 0, s24
  s_add_u32 s23, s23, 1
  s_add_u32 s22, s22, 20480
  s_cmp_eq_u32 s23, 12
  s_cselect_b32 s8, 245760, 0
  s_cselect_b32 s23, 0, s23
  s_sub_u32 s22, s22, s8
  s_waitcnt vmcnt(17)
  s_barrier
  s_add_u32 m0, s37, s92
  s_nop 0
  buffer_load_dwordx4 v10, s[52:55], s25 offen offset:0 sc1 lds
  buffer_load_dwordx4 v10, s[52:55], s25 offen offset:1024 sc1 lds
  buffer_load_dwordx4 v10, s[52:55], s25 offen offset:2048 sc1 lds
  buffer_load_dwordx4 v10, s[52:55], s25 offen offset:3072 sc1 lds
  s_add_u32 s36, s36, 1
  s_add_u32 s25, s25, 16384
  s_cmp_eq_u32 s36, 12
  s_cselect_b32 s8, 196608, 0
  s_cselect_b32 s36, 0, s36
  s_sub_u32 s25, s25, s8
  s_add_u32 s37, s37, 16384
  s_cmp_eq_u32 s37, 81920
  s_cselect_b32 s37, 0, s37
  s_mul_i32 s8, s24, 20480
  s_add_u32 m0, s8, s34
  s_nop 0
  buffer_load_dwordx4 v122, s[52:55], s22 offen offset:0 sc1 lds
  buffer_load_dwordx4 v122, s[52:55], s22 offen offset:1024 sc1 lds
  buffer_load_dwordx4 v122, s[52:55], s22 offen offset:2048 sc1 lds
  buffer_load_dwordx4 v122, s[52:55], s22 offen offset:3072 sc1 lds
  s_add_u32 m0, m0, 4096
  s_nop 0
  buffer_load_dwordx4 v123, s[52:55], s22 offen sc1 lds
  s_add_u32 s24, s24, 1
  s_cmp_eq_u32 s24, 3
  s_cselect_b32 s24, 0, s24
  s_add_u32 s23, s23, 1
  s_add_u32 s22, s22, 20480
  s_cmp_eq_u32 s23, 12
  s_cselect_b32 s8, 245760, 0
  s_cselect_b32 s23, 0, s23
  s_sub_u32 s22, s22, s8
  s_waitcnt vmcnt(9)
  s_barrier
  s_add_u32 m0, s37, s92
  s_nop 0
  buffer_load_dwordx4 v10, s[52:55], s25 offen offset:0 sc1 lds
  buffer_load_dwordx4 v10, s[52:55], s25 offen offset:1024 sc1 lds
  buffer_load_dwordx4 v10, s[52:55], s25 offen offset:2048 sc1 lds
  buffer_load_dwordx4 v10, s[52:55], s25 offen offset:3072 sc1 lds
  s_add_u32 s36, s36, 1
  s_add_u32 s25, s25, 16384
  s_cmp_eq_u32 s36, 12
  s_cselect_b32 s8, 196608, 0
  s_cselect_b32 s36, 0, s36
  s_sub_u32 s25, s25, s8
  s_add_u32 s37, s37, 16384
  s_cmp_eq_u32 s37, 81920
  s_cselect_b32 s37, 0, s37
  s_mul_i32 s8, s24, 20480
  s_add_u32 m0, s8, s34
  s_nop 0
  buffer_load_dwordx4 v122, s[52:55], s22 offen offset:0 sc1 lds
  buffer_load_dwordx4 v122, s[52:55], s22 offen offset:1024 sc1 lds
  buffer_load_dwordx4 v122, s[52:55], s22 offen offset:2048 sc1 lds
  buffer_load_dwordx4 v122, s[52:55], s22 offen offset:3072 sc1 lds
  s_add_u32 m0, m0, 4096
  s_nop 0
  buffer_load_dwordx4 v123, s[52:55], s22 offen sc1 lds
  s_add_u32 s24, s24, 1
  s_cmp_eq_u32 s24, 3
  s_cselect_b32 s24, 0, s24
  s_add_u32 s23, s23, 1
  s_add_u32 s22, s22, 20480
  s_cmp_eq_u32 s23, 12
  s_cselect_b32 s8, 245760, 0
  s_cselect_b32 s23, 0, s23
  s_sub_u32 s22, s22, s8
  s_mov_b32 s101, 7
L_ll_g41:
  s_waitcnt vmcnt(9)
  s_barrier
  s_add_u32 m0, s37, s92
  s_nop 0
  buffer_load_dwordx4 v10, s[52:55], s25 offen offset:0 sc1 lds
  buffer_load_dwordx4 v10, s[52:55], s25 offen offset:1024 sc1 lds
  buffer_load_dwordx4 v10, s[52:55], s25 offen offset:2048 sc1 lds
  buffer_load_dwordx4 v10, s[52:55], s25 offen offset:3072 sc1 lds
  s_add_u32 s36, s36, 1
  s_add_u32 s25, s25, 16384
  s_cmp_eq_u32 s36, 12
  s_cselect_b32 s8, 196608, 0
  s_cselect_b32 s36, 0, s36
  s_sub_u32 s25, s25, s8
  s_add_u32 s37, s37, 16384
  s_cmp_eq_u32 s37, 81920
  s_cselect_b32 s37, 0, s37
  s_mul_i32 s8, s24, 20480
  s_add_u32 m0, s8, s34
  s_nop 0
  buffer_load_dwordx4 v122, s[52:55], s22 offen offset:0 sc1 lds
  buffer_load_dwordx4 v122, s[52:55], s22 offen offset:1024 sc1 lds
  buffer_load_dwordx4 v122, s[52:55], s22 offen offset:2048 sc1 lds
  buffer_load_dwordx4 v122, s[52:55], s22 offen offset:3072 sc1 lds
  s_add_u32 m0, m0, 4096
  s_nop 0
  buffer_load_dwordx4 v123, s[52:55], s22 offen sc1 lds
  s_add_u32 s24, s24, 1
  s_cmp_eq_u32 s24, 3
  s_cselect_b32 s24, 0, s24
  s_add_u32 s23, s23, 1
  s_add_u32 s22, s22, 20480
  s_cmp_eq_u32 s23, 12
  s_cselect_b32 s8, 245760, 0
  s_cselect_b32 s23, 0, s23
  s_sub_u32 s22, s22, s8
  s_sub_u32 s101, s101, 1
  s_cmp_lg_u32 s101, 0
  s_cbranch_scc1 L_ll_g41
  s_waitcnt vmcnt(9)
  s_barrier
  s_mul_i32 s8, s24, 20480
  s_add_u32 m0, s8, s34
  s_nop 0
  buffer_load_dwordx4 v122, s[52:55], s22 offen offset:0 sc1 lds
  buffer_load_dwordx4 v122, s[52:55], s22 offen offset:1024 sc1 lds
  buffer_load_dwordx4 v122, s[52:55], s22 offen offset:2048 sc1 lds
  buffer_load_dwordx4 v122, s[52:55], s22 offen offset:3072 sc1 lds
  s_add_u32 m0, m0, 4096
  s_nop 0
  buffer_load_dwordx4 v123, s[52:55], s22 offen sc1 lds
  s_add_u32 s24, s24, 1
  s_cmp_eq_u32 s24, 3
  s_cselect_b32 s24, 0, s24
  s_add_u32 s23, s23, 1
  s_add_u32 s22, s22, 20480
  s_cmp_eq_u32 s23, 12
  s_cselect_b32 s8, 245760, 0
  s_cselect_b32 s23, 0, s23
  s_sub_u32 s22, s22, s8
  s_waitcnt vmcnt(5)
  s_barrier
  s_mul_i32 s8, s24, 20480
  s_add_u32 m0, s8, s34
  s_nop 0
  buffer_load_dwordx4 v122, s[52:55], s22 offen offset:0 sc1 lds
  buffer_load_dwordx4 v122, s[52:55], s22 offen offset:1024 sc1 lds
  buffer_load_dwordx4 v122, s[52:55], s22 offen offset:2048 sc1 lds
  buffer_load_dwordx4 v122, s[52:55], s22 offen offset:3072 sc1 lds
  s_add_u32 m0, m0, 4096
  s_nop 0
  buffer_load_dwordx4 v123, s[52:55], s22 offen sc1 lds
  s_add_u32 s24, s24, 1
  s_cmp_eq_u32 s24, 3
  s_cselect_b32 s24, 0, s24
  s_add_u32 s23, s23, 1
  s_add_u32 s22, s22, 20480
  s_cmp_eq_u32 s23, 12
  s_cselect_b32 s8, 245760, 0
  s_cselect_b32 s23, 0, s23
  s_sub_u32 s22, s22, s8
  s_waitcnt vmcnt(5)
  s_barrier
  s_waitcnt vmcnt(0)
  s_barrier
  s_waitcnt vmcnt(0)
  s_endpgm
L_code_end:
  s_endpgm
.section .rodata,"a"
.p2align 6
.amdhsa_kernel recurrent_scan__ssm_conv_s5__mixer_s_mlp__prompt_kernel
  .amdhsa_next_free_vgpr 256
  .amdhsa_next_free_sgpr 102
  .amdhsa_accum_offset 256
  .amdhsa_group_segment_fixed_size 0
  .amdhsa_kernarg_size 136
  .amdhsa_user_sgpr_count 2
  .amdhsa_user_sgpr_kernarg_segment_ptr 1
  .amdhsa_system_sgpr_workgroup_id_x 1
  .amdhsa_float_denorm_mode_32 3
.end_amdhsa_kernel
```
